```python
import torch

def _softmax(x, axis=-1):
    return torch.softmax(x, dim=axis)
def _gelu(x):
    return torch.nn.functional.gelu(x, approximate="tanh")
def _silu(x):
    return torch.nn.functional.silu(x)
def _sigmoid(x):
    return torch.sigmoid(x)
def _layernorm(x, axis=-1, eps=1e-5):
    m = x.mean(dim=axis, keepdim=True)
    v = x.var(dim=axis, keepdim=True, unbiased=False)
    return (x - m) / torch.sqrt(v + eps)
def _scatter_add(tgt, idx, src, axis=0):
    return tgt.clone().index_add_(axis, idx, src)
def _segment_sum(src, seg, n):
    out = torch.zeros((n,) + src.shape[1:], dtype=src.dtype)
    return out.index_add_(0, seg, src)
def _pad(x, pw):
    flat = tuple(v for pair in reversed(pw) for v in pair)
    return torch.nn.functional.pad(x, flat)

kernel_name = 'concat_heads__ssm_conv_h3__spectral_fnet__prompt'

def setup_inputs():

    _w = (lambda a: (lambda t: t.to(torch.bfloat16) if t.is_floating_point() else t)(torch.as_tensor(a)))
    def _A_setup():
        B, S, D = 1, 2048, 576
        ks = 4
        return {
            "q": _w((lambda *s: torch.randn(*s, dtype=torch.bfloat16) * 0.05)(B, S, D)),
            "k": _w((lambda *s: torch.randn(*s, dtype=torch.bfloat16) * 3.2)(B, S, D)),
            "v": _w((lambda *s: torch.randn(*s, dtype=torch.bfloat16) * 3.2)(B, S, D)),
            "shift_k": _w((lambda *s: torch.randn(*s, dtype=torch.bfloat16) * 3.2)(D, ks) * 0.5),
            "ssm_k": _w((lambda *s: torch.randn(*s, dtype=torch.bfloat16) * 3.2)(D, S) * (1.0 / S ** 0.5)),
            "ssm_D": _w((lambda *s: torch.randn(*s, dtype=torch.bfloat16) * 3.2)(D)),
        }
    _A_in = _A_setup()

    def _B_setup():
        B, S, D = 1, 2048, 576
        ns = torch.arange(S)[:, None] * torch.arange(S)[None, :]
        nd = torch.arange(D)[:, None] * torch.arange(D)[None, :]
        Ws_re = torch.cos(-2.0 * torch.pi * ns / S).to(float)
        Ws_im = torch.sin(-2.0 * torch.pi * ns / S).to(float)
        Wd_re = torch.cos(-2.0 * torch.pi * nd / D).to(float)
        Wd_im = torch.sin(-2.0 * torch.pi * nd / D).to(float)
        return {
            "x": _w((lambda *s: torch.randn(*s, dtype=torch.bfloat16) * 0.05)(B, S, D)),
            "dft_seq_re": _w(Ws_re),
            "dft_seq_im": _w(Ws_im),
            "dft_hid_re": _w(Wd_re),
            "dft_hid_im": _w(Wd_im),
        }
    _B_in = _B_setup()

    return {
        "A_q": _A_in["q"],
        "A_k": _A_in["k"],
        "A_v": _A_in["v"],
        "A_shift_k": _A_in["shift_k"],
        "A_ssm_k": _A_in["ssm_k"],
        "A_ssm_D": _A_in["ssm_D"],
        "B_x": _B_in["x"],
        "B_dft_seq_re": _B_in["dft_seq_re"],
        "B_dft_seq_im": _B_in["dft_seq_im"],
        "B_dft_hid_re": _B_in["dft_hid_re"],
        "B_dft_hid_im": _B_in["dft_hid_im"],
    }

def reference(A_q, A_k, A_v, A_shift_k, A_ssm_k, A_ssm_D, B_x, B_dft_seq_re, B_dft_seq_im, B_dft_hid_re, B_dft_hid_im):
    def _A_ref(q, k, v, shift_k, ssm_k, ssm_D):
        B, S, D = q.shape
        ks = shift_k.shape[-1]
        k_pad = _pad(k, ((0, 0), (ks - 1, 0), (0, 0)))
        k_shift = torch.zeros_like(k)
        for t in range(ks):
            k_shift = k_shift + k_pad[:, t:t + S, :] * shift_k[:, ks - 1 - t][None, None, :]
        kv = k_shift * v
        L = 2 * S
        kv_pad = _pad(kv, ((0, 0), (0, S), (0, 0)))
        kf_pad = _pad(ssm_k, ((0, 0), (0, S)))
        kv_f = (lambda x, axes=(-2,-1): torch.fft.rfft2(x.float(), dim=axes))(kv_pad[:, None, :, :], axes=(1, 2))
        kf_f = (lambda x, axes=(-2,-1): torch.fft.rfft2(x.float(), dim=axes))(kf_pad[:, None, :], axes=(1, 2))
        kf_f = (lambda x, *d: x.permute(*d))(kf_f, 1, 2, 0)
        y_f = kv_f * kf_f[None, :, :, :]
        y = (lambda x, s, axes=(-2,-1): torch.fft.irfft2(x, s=s, dim=axes).to(torch.bfloat16))(y_f, (1, L), axes=(1, 2))[:, 0, :S, :]
        y = y + kv * ssm_D[None, None, :]
        return q * y

    def _B_ref(x, dft_seq_re, dft_seq_im, dft_hid_re, dft_hid_im):
        a = torch.einsum("bsd,ed->bse", x, dft_hid_re)
        b = torch.einsum("bsd,ed->bse", x, dft_hid_im)
        y = torch.einsum("ts,bse->bte", dft_seq_re, a) - torch.einsum("ts,bse->bte", dft_seq_im, b)
        return y

    a = _A_ref(A_q, A_k, A_v, A_shift_k, A_ssm_k, A_ssm_D)
    b = _B_ref(B_x, B_dft_seq_re, B_dft_seq_im, B_dft_hid_re, B_dft_hid_im)
    return torch.concatenate([a, b], axis=-1)
```

```asm
; @launch grid=(256,1,1) block=(512,1,1) lds=137616
.amdgcn_target "amdgcn-amd-amdhsa--gfx950"
.text
.globl concat_heads__ssm_conv_h3__spectral_fnet__prompt_kernel
.p2align 8
.type concat_heads__ssm_conv_h3__spectral_fnet__prompt_kernel,@function
concat_heads__ssm_conv_h3__spectral_fnet__prompt_kernel:
    s_load_dwordx16 s[8:23], s[0:1], 0
    s_load_dwordx2 s[30:31], s[0:1], 88
    s_load_dwordx4 s[32:35], s[0:1], 96
    s_lshr_b32 s3, s2, 3
    s_and_b32 s48, s2, 7
    v_lshrrev_b32 v2, 6, v0
    v_and_b32 v1, 63, v0
    s_cmp_ge_u32 s2, 256
    v_readfirstlane_b32 s6, v2
    s_cbranch_scc1 L_end
    s_getpc_b64 s[4:5]
L_pc:
    v_lshlrev_b32 v2, 7, v0
    v_min_u32 v2, L_end-L_pc, v2
    global_load_dword v255, v2, s[4:5]
    v_mov_b32 v126, 137600
    v_mov_b32 v127, 0
    ds_write_b32 v126, v127
    s_sub_u32 s7, s2, 32
    s_cmp_lt_u32 s7, 64
    s_cbranch_scc0 L_a0
    s_branch L_b1
L_a0:
    s_cmp_lt_u32 s3, 4
    s_cbranch_scc0 L_a1
    s_cmp_ge_u32 s48, 5
    s_cbranch_scc1 L_misc
    s_lshr_b32 s77, s48, 1
    s_and_b32 s49, s48, 1
    s_lshl_b32 s49, s49, 2
    s_lshr_b32 s50, s48, 2
    s_lshl_b32 s50, s3, s50
    s_add_u32 s76, s49, s50
    s_add_u32 s76, s76, 64
    s_branch L_a2
L_a1:
    s_lshl_b32 s76, s48, 3
    s_sub_u32 s49, s3, 12
    s_and_b32 s77, s49, 1
    s_lshr_b32 s49, s49, 1
    s_sub_u32 s50, s3, 28
    s_lshl_b32 s50, s50, 1
    s_cmp_ge_u32 s3, 28
    s_cselect_b32 s49, s50, s49
    s_cselect_b32 s77, 2, s77
    s_add_u32 s76, s76, s49
L_a2:
    s_cmp_ge_u32 s3, 28
    s_cselect_b32 s49, 1, 4
    s_cselect_b32 s50, 100, -12
    s_lshl_b32 s7, s48, s49
    s_add_u32 s7, s7, s50
    s_add_u32 s7, s7, s3
    s_sub_u32 s78, s3, 12
    s_lshl_b32 s50, s76, 3
    s_add_u32 s50, s50, s6
    s_lshl_b32 s51, s50, 12
    v_lshlrev_b32 v119, 4, v1
    v_lshrrev_b32 v2, 5, v1
    s_cmp_eq_u32 s77, 2
    s_cselect_b32 s52, 31232, 0
    v_add_u32 v14, s51, v119
    v_mad_u32_u24 v15, v2, s52, v14
    v_add_u32 v9, s52, v14
    s_lshr_b32 s72, s7, 4
    s_and_b32 s49, s7, 15
    s_lshl_b32 s73, s49, 3
    s_add_u32 s73, s73, s6
    s_mul_i32 s74, s73, 18432
    s_lshl_b32 s52, s72, 7
    s_add_u32 s74, s74, s52
    s_movk_i32 s54, 4608
    v_and_b32 v7, 31, v1
    v_mul_u32_u24 v4, 9216, v2
    v_lshl_add_u32 v4, v7, 2, v4
    v_add_u32 v4, s74, v4
    v_add_u32 v5, 0xfffff280, v4
    s_lshl_b32 s52, s72, 9
    v_lshlrev_b32 v6, 4, v7
    v_add_u32 v6, s52, v6
    s_mov_b32 s38, 2359296
    s_mov_b32 s39, 0x20000
    s_mov_b32 s42, s38
    s_mov_b32 s43, s39
    s_waitcnt lgkmcnt(0)
    s_mov_b64 s[36:37], s[10:11]
    s_mov_b64 s[40:41], s[12:13]
    s_cmp_lt_u32 s78, 18
    s_cbranch_scc0 L_an0
    global_load_dwordx4 v[128:131], v6, s[14:15]
    buffer_load_dword v132, v5, s[36:39], 0 offen offset:0 nt
    buffer_load_dword v133, v5, s[36:39], 0 offen offset:1152 nt
    buffer_load_dword v134, v5, s[36:39], 0 offen offset:2304 nt
    buffer_load_dword v135, v4, s[36:39], 0 offen offset:0 nt
    buffer_load_dword v143, v4, s[40:43], 0 offen offset:0 nt
    buffer_load_dword v136, v4, s[36:39], 0 offen offset:1152 nt
    buffer_load_dword v144, v4, s[40:43], 0 offen offset:1152 nt
    buffer_load_dword v137, v4, s[36:39], 0 offen offset:2304 nt
    buffer_load_dword v145, v4, s[40:43], 0 offen offset:2304 nt
    buffer_load_dword v138, v4, s[36:39], 0 offen offset:3456 nt
    buffer_load_dword v146, v4, s[40:43], 0 offen offset:3456 nt
    buffer_load_dword v139, v4, s[36:39], s54 offen offset:0 nt
    buffer_load_dword v147, v4, s[40:43], s54 offen offset:0 nt
    buffer_load_dword v140, v4, s[36:39], s54 offen offset:1152 nt
    buffer_load_dword v148, v4, s[40:43], s54 offen offset:1152 nt
    buffer_load_dword v141, v4, s[36:39], s54 offen offset:2304 nt
    buffer_load_dword v149, v4, s[40:43], s54 offen offset:2304 nt
    buffer_load_dword v142, v4, s[36:39], s54 offen offset:3456 nt
    buffer_load_dword v150, v4, s[40:43], s54 offen offset:3456 nt
L_an0:
    s_barrier
    s_cmp_eq_u32 s77, 0
    s_cbranch_scc1 L_ah0a
    global_load_dwordx4 v[46:49], v15, s[16:17] offset:1024 nt
    global_load_dwordx4 v[40:43], v14, s[16:17] offset:0 nt
    s_branch L_ah1a
L_ah0a:
    global_load_dwordx4 v[58:61], v14, s[16:17] offset:3072 nt
    global_load_dwordx4 v[52:55], v9, s[16:17] offset:2048 nt
L_ah1a:
    s_add_u32 s26, s34, 5308416
    s_addc_u32 s27, s35, 0
    s_load_dwordx2 s[28:29], s[26:27], 0
    s_and_b32 s52, s50, -2
    s_lshl_b32 s52, s52, 1
    s_load_dword s53, s[18:19], s52
    s_cmp_eq_u32 s77, 2
    s_cselect_b32 s51, 16, 0
    s_add_u32 s52, s52, s51
    s_load_dword s65, s[18:19], s52
    s_lshl_b32 s52, s72, 18
    s_lshl_b32 s49, s73, 8
    s_add_u32 s52, s52, s49
    v_bfe_u32 v124, v1, 2, 3
    v_lshlrev_b32 v124, 15, v124
    v_and_b32 v125, 48, v119
    v_lshl_add_u32 v116, v2, 6, v125
    v_add3_u32 v116, v116, v124, s52
    s_mul_i32 s55, s6, 17200
    v_lshrrev_b32 v124, 2, v1
    v_lshlrev_b32 v117, 8, v124
    v_add3_u32 v117, v117, v125, s55
    v_and_b32 v124, 1, v124
    v_lshlrev_b32 v124, 6, v124
    v_sub_u32 v118, v117, v124
    v_add_u32 v117, v117, v124
    s_lshr_b32 s52, s6, 1
    s_sub_u32 s49, 3, s77
    s_cmp_eq_u32 s77, 2
    s_cselect_b32 s49, 5, s49
    s_cselect_b32 s52, 0, s52
    s_cselect_b32 s51, 0, 2
    v_min_u32 v123, s49, v1
    v_lshlrev_b32 v123, s51, v123
    v_add_u32 v123, s52, v123
    s_lshr_b32 s52, s76, 3
    s_add_u32 s52, s52, 96
    v_lshl_add_u32 v122, v123, 3, s52
    s_cmp_lt_u32 s76, 64
    s_cselect_b32 s64, 0, 32768
    s_cbranch_scc1 L_af
    v_and_b32 v122, 1, v123
    v_lshrrev_b32 v123, 1, v123
    v_lshl_add_u32 v122, v122, 3, v123
    v_add_u32 v122, 224, v122
L_af:
    v_lshlrev_b32 v122, 7, v122
    v_add_u32 v122, 5242880, v122
    global_load_dword v254, v122, s[34:35] sc1
    s_mov_b64 s[56:57], s[34:35]
    s_mov_b32 s58, 268435456
    s_mov_b32 s59, 0x20000
    v_min_u32 v124, 464, v119
    v_add_u32 v124, s55, v124
    v_mov_b32 v16, 0
    v_mov_b32 v17, 0
    v_mov_b32 v18, 0
    v_mov_b32 v19, 0
    v_mov_b32 v20, 0
    v_mov_b32 v21, 0
    v_mov_b32 v22, 0
    v_mov_b32 v23, 0
    v_mov_b32 v24, 0
    v_mov_b32 v25, 0
    v_mov_b32 v26, 0
    v_mov_b32 v27, 0
    v_mov_b32 v28, 0
    v_mov_b32 v29, 0
    v_mov_b32 v30, 0
    v_mov_b32 v31, 0
    v_mov_b32 v32, 0
    v_mov_b32 v33, 0
    v_mov_b32 v34, 0
    v_mov_b32 v35, 0
    v_mov_b32 v36, 0
    v_mov_b32 v37, 0
    v_mov_b32 v38, 0
    v_mov_b32 v39, 0
    ds_write_b128 v124, v[16:19] offset:16640
    v_and_b32 v2, 15, v1
    v_lshrrev_b32 v3, 4, v1
    v_lshrrev_b32 v4, 2, v2
    v_lshl_add_u32 v4, v3, 1, v4
    v_add_u32 v5, 5, v4
    v_add_u32 v4, 4, v4
    v_and_b32 v125, 3, v2
    v_lshrrev_b32 v123, 3, v4
    v_and_b32 v4, 7, v4
    v_lshlrev_b32 v4, 3, v4
    v_lshl_add_u32 v4, v123, 8, v4
    v_xor_b32 v123, v123, v125
    v_lshl_add_u32 v4, v123, 6, v4
    v_xor_b32 v6, 64, v4
    v_add_u32 v4, s55, v4
    v_add_u32 v6, s55, v6
    v_lshrrev_b32 v123, 3, v5
    v_and_b32 v5, 7, v5
    v_lshlrev_b32 v5, 3, v5
    v_lshl_add_u32 v5, v123, 8, v5
    v_xor_b32 v123, v123, v125
    v_lshl_add_u32 v5, v123, 6, v5
    v_xor_b32 v7, 64, v5
    v_add_u32 v5, s55, v5
    v_add_u32 v7, s55, v7
    s_add_u32 s49, s55, 10528
    v_sub_u32 v8, 15, v2
    v_lshlrev_b32 v8, 5, v8
    v_lshl_add_u32 v8, v3, 4, v8
    v_add_u32 v8, s49, v8
    v_lshrrev_b32 v123, 2, v2
    v_xor_b32 v120, 1, v123
    v_lshlrev_b32 v120, 6, v120
    v_lshl_add_u32 v120, v125, 3, v120
    v_add_u32 v120, s55, v120
    v_sub_u32 v121, 3, v123
    v_lshlrev_b32 v121, 4, v121
    v_cmp_eq_u32 s[68:69], 3, v125
    s_lshl_b32 s60, s76, 15
    v_lshlrev_b32 v12, 4, v0
    v_bfe_u32 v123, v0, 3, 1
    v_lshl_add_u32 v123, v125, 1, v123
    v_mul_u32_u24 v13, 17200, v123
    v_lshrrev_b32 v123, 4, v0
    v_bfe_u32 v124, v0, 2, 1
    v_lshl_add_u32 v123, v123, 1, v124
    v_sub_u32 v123, 63, v123
    v_lshl_add_u32 v13, v123, 4, v13
    v_add_u32 v13, 12544, v13
    s_cmp_lt_u32 s78, 18
    s_cbranch_scc0 L_an1
    s_waitcnt vmcnt(19)
    v_lshlrev_b32 v152, 16, v128
    v_lshlrev_b32 v153, 16, v130
    v_and_b32 v154, 0xffff0000, v128
    v_and_b32 v155, 0xffff0000, v130
    v_lshlrev_b32 v156, 16, v129
    v_lshlrev_b32 v157, 16, v131
    v_and_b32 v158, 0xffff0000, v129
    v_and_b32 v159, 0xffff0000, v131
    v_lshlrev_b32 v160, 16, v132
    v_and_b32 v161, 0xffff0000, v132
    v_lshlrev_b32 v162, 16, v133
    v_and_b32 v163, 0xffff0000, v133
    v_lshlrev_b32 v164, 16, v134
    v_and_b32 v165, 0xffff0000, v134
    v_pk_mul_f32 v[184:185], v[158:159], v[160:161]
    v_pk_fma_f32 v[184:185], v[156:157], v[162:163], v[184:185]
    v_pk_fma_f32 v[184:185], v[154:155], v[164:165], v[184:185]
    s_waitcnt vmcnt(17)
    v_lshlrev_b32 v166, 16, v135
    v_and_b32 v167, 0xffff0000, v135
    v_lshlrev_b32 v182, 16, v143
    v_and_b32 v183, 0xffff0000, v143
    v_pk_fma_f32 v[184:185], v[152:153], v[166:167], v[184:185]
    v_pk_mul_f32 v[184:185], v[184:185], v[182:183]
    v_pk_mul_f32 v[186:187], v[158:159], v[162:163]
    v_pk_fma_f32 v[186:187], v[156:157], v[164:165], v[186:187]
    v_pk_fma_f32 v[186:187], v[154:155], v[166:167], v[186:187]
    s_waitcnt vmcnt(15)
    v_lshlrev_b32 v168, 16, v136
    v_and_b32 v169, 0xffff0000, v136
    v_lshlrev_b32 v182, 16, v144
    v_and_b32 v183, 0xffff0000, v144
    v_pk_fma_f32 v[186:187], v[152:153], v[168:169], v[186:187]
    v_pk_mul_f32 v[186:187], v[186:187], v[182:183]
    v_cvt_pk_bf16_f32 v203, v186, v184
    v_cvt_pk_bf16_f32 v207, v187, v185
    v_pk_mul_f32 v[188:189], v[158:159], v[164:165]
    v_pk_fma_f32 v[188:189], v[156:157], v[166:167], v[188:189]
    v_pk_fma_f32 v[188:189], v[154:155], v[168:169], v[188:189]
    s_waitcnt vmcnt(13)
    v_lshlrev_b32 v170, 16, v137
    v_and_b32 v171, 0xffff0000, v137
    v_lshlrev_b32 v182, 16, v145
    v_and_b32 v183, 0xffff0000, v145
    v_pk_fma_f32 v[188:189], v[152:153], v[170:171], v[188:189]
    v_pk_mul_f32 v[188:189], v[188:189], v[182:183]
    v_pk_mul_f32 v[190:191], v[158:159], v[166:167]
    v_pk_fma_f32 v[190:191], v[156:157], v[168:169], v[190:191]
    v_pk_fma_f32 v[190:191], v[154:155], v[170:171], v[190:191]
    s_waitcnt vmcnt(11)
    v_lshlrev_b32 v172, 16, v138
    v_and_b32 v173, 0xffff0000, v138
    v_lshlrev_b32 v182, 16, v146
    v_and_b32 v183, 0xffff0000, v146
    v_pk_fma_f32 v[190:191], v[152:153], v[172:173], v[190:191]
    v_pk_mul_f32 v[190:191], v[190:191], v[182:183]
    v_cvt_pk_bf16_f32 v202, v190, v188
    v_cvt_pk_bf16_f32 v206, v191, v189
    v_pk_mul_f32 v[192:193], v[158:159], v[168:169]
    v_pk_fma_f32 v[192:193], v[156:157], v[170:171], v[192:193]
    v_pk_fma_f32 v[192:193], v[154:155], v[172:173], v[192:193]
    s_waitcnt vmcnt(9)
    v_lshlrev_b32 v174, 16, v139
    v_and_b32 v175, 0xffff0000, v139
    v_lshlrev_b32 v182, 16, v147
    v_and_b32 v183, 0xffff0000, v147
    v_pk_fma_f32 v[192:193], v[152:153], v[174:175], v[192:193]
    v_pk_mul_f32 v[192:193], v[192:193], v[182:183]
    v_pk_mul_f32 v[194:195], v[158:159], v[170:171]
    v_pk_fma_f32 v[194:195], v[156:157], v[172:173], v[194:195]
    v_pk_fma_f32 v[194:195], v[154:155], v[174:175], v[194:195]
    s_waitcnt vmcnt(7)
    v_lshlrev_b32 v176, 16, v140
    v_and_b32 v177, 0xffff0000, v140
    v_lshlrev_b32 v182, 16, v148
    v_and_b32 v183, 0xffff0000, v148
    v_pk_fma_f32 v[194:195], v[152:153], v[176:177], v[194:195]
    v_pk_mul_f32 v[194:195], v[194:195], v[182:183]
    v_cvt_pk_bf16_f32 v201, v194, v192
    v_cvt_pk_bf16_f32 v205, v195, v193
    v_pk_mul_f32 v[196:197], v[158:159], v[172:173]
    v_pk_fma_f32 v[196:197], v[156:157], v[174:175], v[196:197]
    v_pk_fma_f32 v[196:197], v[154:155], v[176:177], v[196:197]
    s_waitcnt vmcnt(5)
    v_lshlrev_b32 v178, 16, v141
    v_and_b32 v179, 0xffff0000, v141
    v_lshlrev_b32 v182, 16, v149
    v_and_b32 v183, 0xffff0000, v149
    v_pk_fma_f32 v[196:197], v[152:153], v[178:179], v[196:197]
    v_pk_mul_f32 v[196:197], v[196:197], v[182:183]
    v_pk_mul_f32 v[198:199], v[158:159], v[174:175]
    v_pk_fma_f32 v[198:199], v[156:157], v[176:177], v[198:199]
    v_pk_fma_f32 v[198:199], v[154:155], v[178:179], v[198:199]
    s_waitcnt vmcnt(3)
    v_lshlrev_b32 v180, 16, v142
    v_and_b32 v181, 0xffff0000, v142
    v_lshlrev_b32 v182, 16, v150
    v_and_b32 v183, 0xffff0000, v150
    v_pk_fma_f32 v[198:199], v[152:153], v[180:181], v[198:199]
    v_pk_mul_f32 v[198:199], v[198:199], v[182:183]
    v_cvt_pk_bf16_f32 v200, v198, v196
    v_cvt_pk_bf16_f32 v204, v199, v197
    global_store_dwordx4 v116, v[200:203], s[34:35] sc1
    global_store_dwordx4 v116, v[204:207], s[34:35] offset:128 sc1
    s_branch L_an2
L_an1:
    global_load_dword v254, v122, s[34:35] sc1
    global_load_dword v254, v122, s[34:35] sc1
L_an2:
    s_cmp_eq_u32 s77, 1
    s_cbranch_scc1 L_aq
    s_cmp_eq_u32 s77, 2
    s_cbranch_scc1 L_al
    global_load_dwordx4 v[46:49], v15, s[16:17] offset:1024 nt
    global_load_dwordx4 v[40:43], v14, s[16:17] offset:0 nt
    s_waitcnt lgkmcnt(0)
    s_mul_i32 s28, s28, 0x9e3779b1
    s_add_u32 s28, s28, 0x7f4a7c15
    s_mul_i32 s29, s29, 0x85ebca6d
    s_add_u32 s29, s29, 0x165667b1
    s_lshl_b32 s48, s76, 4
    v_bfe_u32 v123, v1, 2, 2
    v_mul_u32_u24 v10, 17200, v123
    v_and_b32 v124, 3, v1
    s_add_u32 s61, s60, 8192
    s_add_u32 s62, s60, 16384
    s_add_u32 s63, s60, 24576
    s_lshl_b32 s49, s6, 6
    s_add_u32 s49, s49, 1536
    v_add_u32 v123, s49, v1
    v_mul_u32_u24 v14, 1152, v123
    v_add_u32 v14, s48, v14
    v_mul_u32_u24 v15, 2304, v123
    v_add_u32 v15, s48, v15
    v_mul_u32_u24 v9, 192, v3
    v_lshl_add_u32 v9, v2, 3, v9
    v_add_u32 v9, s55, v9
    v_mul_u32_u24 v124, 192, v124
    v_lshl_add_u32 v124, v3, 3, v124
    s_lshr_b32 s49, s6, 2
    s_mul_i32 s49, s49, 768
    s_and_b32 s52, s6, 3
    s_lshl_b32 s52, s52, 5
    s_add_u32 s49, s49, s52
    v_add3_u32 v10, v10, v124, s49
    v_add_u32 v11, 68800, v10
    s_bitcmp1_b32 s50, 0
    s_cselect_b32 s52, 16, 0
    v_lshl_add_u32 v123, v3, 3, v2
    v_sub_u32 v123, 15, v123
    v_and_b32 v124, 1, v123
    v_lshlrev_b32 v124, 4, v124
    v_ashrrev_i32 v123, 1, v123
    s_lshr_b32 s53, s53, s52
    s_and_b32 s53, s53, 0xffff
    v_lshlrev_b32 v125, v124, s53
    v_cmp_eq_u32 vcc, 0, v123
    s_nop 1
    v_cndmask_b32 v88, 0, v125, vcc
    v_cmp_eq_u32 vcc, 1, v123
    s_nop 1
    v_cndmask_b32 v89, 0, v125, vcc
    v_cmp_eq_u32 vcc, 2, v123
    s_nop 1
    v_cndmask_b32 v90, 0, v125, vcc
    v_cmp_eq_u32 vcc, 3, v123
    s_nop 1
    v_cndmask_b32 v91, 0, v125, vcc
    s_waitcnt vmcnt(6)
    v_mov_b32 v64, v59
    v_mov_b32 v65, v60
    v_mov_b32 v66, v61
    v_alignbit_b32 v68, v59, v58, 16
    v_alignbit_b32 v69, v60, v59, 16
    v_alignbit_b32 v70, v61, v60, 16
    v_mov_b32_dpp v62, v58 wave_shl:1 row_mask:0xf bank_mask:0xf
    v_mov_b32_dpp v63, v59 wave_shl:1 row_mask:0xf bank_mask:0xf
    ds_write_b128 v118, v[60:63] offset:12736
    v_mov_b32 v67, v62
    ds_write_b128 v118, v[64:67] offset:12608
    v_alignbit_b32 v71, v62, v61, 16
    ds_write_b128 v117, v[68:71] offset:12544
    v_mov_b32 v72, v69
    v_mov_b32 v73, v70
    v_mov_b32 v74, v71
    v_alignbit_b32 v75, v63, v62, 16
    ds_write_b128 v117, v[72:75] offset:12672
    s_waitcnt vmcnt(5)
    v_readfirstlane_b32 s66, v58
    v_readfirstlane_b32 s67, v59
    v_mov_b32 v76, v53
    v_mov_b32 v77, v54
    v_mov_b32 v78, v55
    v_mov_b32 v56, s66
    v_mov_b32 v57, s67
    v_alignbit_b32 v80, v53, v52, 16
    v_alignbit_b32 v81, v54, v53, 16
    v_alignbit_b32 v82, v55, v54, 16
    v_mov_b32_dpp v56, v52 wave_shl:1 row_mask:0xf bank_mask:0xf
    v_mov_b32_dpp v57, v53 wave_shl:1 row_mask:0xf bank_mask:0xf
    ds_write_b128 v118, v[54:57] offset:8640
    v_mov_b32 v79, v56
    ds_write_b128 v118, v[76:79] offset:8512
    v_alignbit_b32 v83, v56, v55, 16
    ds_write_b128 v117, v[80:83] offset:8448
    v_mov_b32 v84, v81
    v_mov_b32 v85, v82
    v_mov_b32 v86, v83
    v_alignbit_b32 v87, v57, v56, 16
    ds_write_b128 v117, v[84:87] offset:8576
    s_mov_b32 s75, 0
    s_waitcnt vmcnt(2)
    v_mov_b32 v126, 137600
    v_mov_b32 v127, 1
    s_mov_b64 exec, 1
    ds_add_rtn_u32 v126, v126, v127
    s_waitcnt lgkmcnt(0)
    v_cmp_eq_u32 vcc, 7, v126
    s_nop 0
    s_cbranch_vccz Lpub_1
    s_lshl_b32 s49, s2, 7
    s_add_u32 s49, s49, 5242880
    v_mov_b32 v125, s49
    v_mov_b32 v126, s28
    v_mov_b32 v127, s29
    global_store_dwordx2 v125, v[126:127], s[34:35]
    v_add_u32 v125, 32768, v125
    global_store_dwordx2 v125, v[126:127], s[34:35] sc1
Lpub_1d:
    s_mov_b32 s75, 1
Lpub_1:
    s_mov_b64 exec, -1
    ds_read_b64 v[128:129], v6 offset:14336
    ds_read_b64 v[130:131], v7 offset:14336
    ds_read_b64 v[132:133], v4 offset:14592
    ds_read_b64 v[134:135], v5 offset:14592
    ds_read_b64 v[136:137], v6 offset:14848
    ds_read_b64 v[138:139], v7 offset:14848
    ds_read_b64 v[140:141], v4 offset:15104
    ds_read_b64 v[142:143], v5 offset:15104
    ds_read_b64 v[144:145], v6 offset:15360
    ds_read_b64 v[146:147], v7 offset:15360
    ds_read_b64 v[148:149], v4 offset:15616
    ds_read_b64 v[150:151], v5 offset:15616
    ds_read_b64 v[152:153], v6 offset:15872
    ds_read_b64 v[154:155], v7 offset:15872
    ds_read_b64 v[156:157], v4 offset:16128
    ds_read_b64 v[158:159], v5 offset:16128
    ds_read_b64 v[160:161], v6 offset:12288
    ds_read_b64 v[162:163], v7 offset:12288
    ds_read_b64 v[164:165], v4 offset:12544
    ds_read_b64 v[166:167], v5 offset:12544
    ds_read_b64 v[168:169], v6 offset:12800
    ds_read_b64 v[170:171], v7 offset:12800
    ds_read_b64 v[172:173], v4 offset:13056
    ds_read_b64 v[174:175], v5 offset:13056
    ds_read_b64 v[176:177], v6 offset:13312
    ds_read_b64 v[178:179], v7 offset:13312
    ds_read_b64 v[180:181], v4 offset:13568
    ds_read_b64 v[182:183], v5 offset:13568
    ds_read_b64 v[184:185], v6 offset:13824
    ds_read_b64 v[186:187], v7 offset:13824
    ds_read_b64 v[188:189], v4 offset:14080
    ds_read_b64 v[190:191], v5 offset:14080
    s_cmp_eq_u32 s75, 1
    s_waitcnt vmcnt(2)
    s_cbranch_scc1 Lpub_1w
    s_waitcnt vmcnt(0)
Lpub_1w:
    v_readfirstlane_b32 s66, v52
    v_readfirstlane_b32 s67, v53
    v_mov_b32 v64, v47
    v_mov_b32 v65, v48
    v_mov_b32 v66, v49
    v_mov_b32 v50, s66
    v_mov_b32 v51, s67
    v_alignbit_b32 v68, v47, v46, 16
    v_alignbit_b32 v69, v48, v47, 16
    v_alignbit_b32 v70, v49, v48, 16
    v_mov_b32_dpp v50, v46 wave_shl:1 row_mask:0xf bank_mask:0xf
    v_mov_b32_dpp v51, v47 wave_shl:1 row_mask:0xf bank_mask:0xf
    ds_write_b128 v118, v[48:51] offset:4544
    v_mov_b32 v67, v50
    ds_write_b128 v118, v[64:67] offset:4416
    v_alignbit_b32 v71, v50, v49, 16
    ds_write_b128 v117, v[68:71] offset:4352
    v_mov_b32 v72, v69
    v_mov_b32 v73, v70
    v_mov_b32 v74, v71
    v_alignbit_b32 v75, v51, v50, 16
    ds_write_b128 v117, v[72:75] offset:4480
    v_readfirstlane_b32 s66, v46
    v_readfirstlane_b32 s67, v47
    v_mov_b32 v76, v41
    v_mov_b32 v77, v42
    v_mov_b32 v78, v43
    v_mov_b32 v44, s66
    v_mov_b32 v45, s67
    v_alignbit_b32 v80, v41, v40, 16
    v_alignbit_b32 v81, v42, v41, 16
    v_alignbit_b32 v82, v43, v42, 16
    v_mov_b32_dpp v44, v40 wave_shl:1 row_mask:0xf bank_mask:0xf
    v_mov_b32_dpp v45, v41 wave_shl:1 row_mask:0xf bank_mask:0xf
    ds_write_b128 v118, v[42:45] offset:448
    v_mov_b32 v79, v44
    ds_write_b128 v118, v[76:79] offset:320
    v_alignbit_b32 v83, v44, v43, 16
    ds_write_b128 v117, v[80:83] offset:256
    v_mov_b32 v84, v81
    v_mov_b32 v85, v82
    v_mov_b32 v86, v83
    v_alignbit_b32 v87, v45, v44, 16
    ds_write_b128 v117, v[84:87] offset:384
    v_readfirstlane_b32 s66, v40
    v_readfirstlane_b32 s67, v41
    s_nop 1
    v_lshlrev_b64 v[96:97], v121, s[66:67]
    v_cndmask_b32_e64 v96, 0, v96, s[68:69]
    v_cndmask_b32_e64 v97, 0, v97, s[68:69]
    ds_write_b64 v120, v[96:97] offset:32
    s_and_b32 s49, s76, 7
    s_mul_i32 s49, s49, 64
    s_mul_i32 s52, s6, 8
    s_add_u32 s49, s49, s52
    s_add_u32 s49, s49, 1536
    s_mul_i32 s49, s49, 1152
    s_lshr_b32 s52, s76, 3
    s_lshl_b32 s52, s52, 7
    s_add_u32 s49, s49, s52
    v_lshrrev_b32 v123, 3, v1
    v_mul_u32_u24 v123, 1152, v123
    v_and_b32 v124, 7, v1
    v_lshl_add_u32 v123, v124, 4, v123
    v_add_u32 v125, s49, v123
    buffer_load_dwordx2 v[126:127], v122, s[56:59], s64 offen sc1
    s_waitcnt lgkmcnt(0)
    s_barrier
    s_mov_b32 s49, 0
    s_branch Lpc_4
Lp_2:
    s_and_b32 s52, s49, 15
    s_cmp_eq_u32 s52, 15
    s_cselect_b32 s52, 32768, s64
    buffer_load_dwordx2 v[126:127], v122, s[56:59], s52 offen sc1
Lpc_4:
    s_add_u32 s49, s49, 1
    s_cmp_gt_u32 s49, 0x100000
    s_waitcnt vmcnt(0)
    v_cmp_ne_u64 vcc, s[28:29], v[126:127]
    s_cbranch_scc1 Lpx_3
    s_cbranch_vccnz Lp_2
Lpx_3:
Lpub_1f:
    buffer_load_dwordx4 v[100:103], v12, s[56:59], s60 offen sc1
    buffer_load_dwordx4 v[104:107], v12, s[56:59], s61 offen sc1
    buffer_load_dwordx4 v[108:111], v12, s[56:59], s62 offen sc1
    buffer_load_dwordx4 v[112:115], v12, s[56:59], s63 offen sc1
    ds_read_b64 v[192:193], v6 offset:10240
    ds_read_b64 v[194:195], v7 offset:10240
    ds_read_b64 v[196:197], v4 offset:10496
    ds_read_b64 v[198:199], v5 offset:10496
    ds_read_b64 v[200:201], v6 offset:10752
    ds_read_b64 v[202:203], v7 offset:10752
    ds_read_b64 v[204:205], v4 offset:11008
    ds_read_b64 v[206:207], v5 offset:11008
    ds_read_b64 v[208:209], v6 offset:11264
    ds_read_b64 v[210:211], v7 offset:11264
    ds_read_b64 v[212:213], v4 offset:11520
    ds_read_b64 v[214:215], v5 offset:11520
    ds_read_b64 v[216:217], v6 offset:11776
    ds_read_b64 v[218:219], v7 offset:11776
    ds_read_b64 v[220:221], v4 offset:12032
    ds_read_b64 v[222:223], v5 offset:12032
    ds_read_b64 v[224:225], v6 offset:8192
    ds_read_b64 v[226:227], v7 offset:8192
    ds_read_b64 v[228:229], v4 offset:8448
    ds_read_b64 v[230:231], v5 offset:8448
    ds_read_b64 v[232:233], v6 offset:8704
    ds_read_b64 v[234:235], v7 offset:8704
    ds_read_b64 v[236:237], v4 offset:8960
    ds_read_b64 v[238:239], v5 offset:8960
    ds_read_b64 v[240:241], v6 offset:9216
    ds_read_b64 v[242:243], v7 offset:9216
    ds_read_b64 v[244:245], v4 offset:9472
    ds_read_b64 v[246:247], v5 offset:9472
    ds_read_b64 v[248:249], v6 offset:9728
    ds_read_b64 v[250:251], v7 offset:9728
    ds_read_b64 v[252:253], v4 offset:9984
    ds_read_b64 v[254:255], v5 offset:9984
    ds_read_b64 v[40:41], v6 offset:0
    ds_read_b64 v[42:43], v7 offset:0
    ds_read_b64 v[44:45], v6 offset:2048
    ds_read_b64 v[46:47], v7 offset:2048
    ds_read_b64 v[48:49], v6 offset:4096
    ds_read_b64 v[50:51], v7 offset:4096
    ds_read_b64 v[52:53], v6 offset:6144
    ds_read_b64 v[54:55], v7 offset:6144
    s_waitcnt vmcnt(3)
    ds_write_b128 v13, v[100:103] offset:3072
    s_waitcnt vmcnt(2)
    ds_write_b128 v13, v[104:107] offset:2048
    s_waitcnt vmcnt(1)
    ds_write_b128 v13, v[108:111] offset:1024
    s_waitcnt vmcnt(0)
    ds_write_b128 v13, v[112:115] offset:0
    s_waitcnt lgkmcnt(0)
    s_barrier
    global_load_dwordx4 v[100:103], v125, s[8:9] nt
    s_cmp_lt_u32 s76, 64
    s_cbranch_scc1 Lc8_5
    s_bitcmp1_b32 s76, 2
    s_cselect_b32 s49, 0, 589824
    s_sub_u32 s49, s49, 294912
    v_add_u32 v125, s49, v125
    global_load_dwordx4 v[100:103], v125, s[8:9] nt
Lc8_5:
    ds_read_b128 v[56:59], v8 offset:4576
    ds_read_b128 v[60:63], v8 offset:5088
    ds_read_b128 v[64:67], v8 offset:5600
    ds_read_b128 v[68:71], v8 offset:2016
    ds_read_b128 v[72:75], v8 offset:2528
    ds_read_b128 v[76:79], v8 offset:3040
    ds_read_b128 v[80:83], v8 offset:3552
    ds_read_b128 v[84:87], v8 offset:4064
    s_setprio 3
    s_waitcnt lgkmcnt(7)
    v_mfma_f32_16x16x32_bf16 v[16:19], v[224:227], v[56:59], v[16:19]
    v_mfma_f32_16x16x32_bf16 v[20:23], v[192:195], v[56:59], v[20:23]
    ds_read_b128 v[56:59], v8 offset:4640
    s_waitcnt lgkmcnt(7)
    v_mfma_f32_16x16x32_bf16 v[16:19], v[192:195], v[60:63], v[16:19]
    v_mfma_f32_16x16x32_bf16 v[20:23], v[160:163], v[60:63], v[20:23]
    ds_read_b128 v[60:63], v8 offset:5152
    s_waitcnt lgkmcnt(7)
    v_mfma_f32_16x16x32_bf16 v[16:19], v[160:163], v[64:67], v[16:19]
    v_mfma_f32_16x16x32_bf16 v[20:23], v[128:131], v[64:67], v[20:23]
    ds_read_b128 v[64:67], v8 offset:5664
    s_waitcnt lgkmcnt(7)
    v_mfma_f32_16x16x32_bf16 v[20:23], v[40:43], v[68:71], v[20:23]
    v_mfma_f32_16x16x32_bf16 v[20:23], v[88:91], v[68:71], v[20:23]
    ds_read_b64 v[68:69], v4 offset:256
    ds_read_b64 v[70:71], v5 offset:256
    s_waitcnt lgkmcnt(8)
    v_mfma_f32_16x16x32_bf16 v[16:19], v[40:43], v[72:75], v[16:19]
    v_mfma_f32_16x16x32_bf16 v[16:19], v[88:91], v[72:75], v[16:19]
    ds_read_b128 v[40:43], v8 offset:2080
    v_mfma_f32_16x16x32_bf16 v[20:23], v[44:47], v[72:75], v[20:23]
    ds_read_b128 v[72:75], v8 offset:2592
    s_waitcnt lgkmcnt(9)
    v_mfma_f32_16x16x32_bf16 v[16:19], v[44:47], v[76:79], v[16:19]
    ds_read_b64 v[44:45], v4 offset:2304
    ds_read_b64 v[46:47], v5 offset:2304
    v_mfma_f32_16x16x32_bf16 v[20:23], v[48:51], v[76:79], v[20:23]
    ds_read_b128 v[76:79], v8 offset:3104
    s_waitcnt lgkmcnt(11)
    v_mfma_f32_16x16x32_bf16 v[16:19], v[48:51], v[80:83], v[16:19]
    ds_read_b64 v[48:49], v4 offset:4352
    ds_read_b64 v[50:51], v5 offset:4352
    v_mfma_f32_16x16x32_bf16 v[20:23], v[52:55], v[80:83], v[20:23]
    ds_read_b128 v[80:83], v8 offset:3616
    s_waitcnt lgkmcnt(13)
    v_mfma_f32_16x16x32_bf16 v[16:19], v[52:55], v[84:87], v[16:19]
    ds_read_b64 v[52:53], v4 offset:6400
    ds_read_b64 v[54:55], v5 offset:6400
    v_mfma_f32_16x16x32_bf16 v[20:23], v[224:227], v[84:87], v[20:23]
    ds_read_b128 v[84:87], v8 offset:4128
    s_waitcnt lgkmcnt(15)
    v_mfma_f32_16x16x32_bf16 v[16:19], v[228:231], v[56:59], v[16:19]
    v_mfma_f32_16x16x32_bf16 v[20:23], v[196:199], v[56:59], v[20:23]
    ds_read_b128 v[56:59], v8 offset:4704
    s_waitcnt lgkmcnt(15)
    v_mfma_f32_16x16x32_bf16 v[16:19], v[196:199], v[60:63], v[16:19]
    v_mfma_f32_16x16x32_bf16 v[20:23], v[164:167], v[60:63], v[20:23]
    ds_read_b128 v[60:63], v8 offset:5216
    s_waitcnt lgkmcnt(15)
    v_mfma_f32_16x16x32_bf16 v[16:19], v[164:167], v[64:67], v[16:19]
    v_mfma_f32_16x16x32_bf16 v[20:23], v[132:135], v[64:67], v[20:23]
    ds_read_b128 v[64:67], v8 offset:5728
    s_waitcnt lgkmcnt(13)
    v_mfma_f32_16x16x32_bf16 v[20:23], v[68:71], v[40:43], v[20:23]
    ds_read_b64 v[40:41], v6 offset:512
    ds_read_b64 v[42:43], v7 offset:512
    s_waitcnt lgkmcnt(14)
    v_mfma_f32_16x16x32_bf16 v[16:19], v[68:71], v[72:75], v[16:19]
    ds_read_b128 v[68:71], v8 offset:2144
    s_waitcnt lgkmcnt(13)
    v_mfma_f32_16x16x32_bf16 v[20:23], v[44:47], v[72:75], v[20:23]
    ds_read_b128 v[72:75], v8 offset:2656
    s_waitcnt lgkmcnt(13)
    v_mfma_f32_16x16x32_bf16 v[16:19], v[44:47], v[76:79], v[16:19]
    ds_read_b64 v[44:45], v6 offset:2560
    ds_read_b64 v[46:47], v7 offset:2560
    s_waitcnt lgkmcnt(13)
    v_mfma_f32_16x16x32_bf16 v[20:23], v[48:51], v[76:79], v[20:23]
    ds_read_b128 v[76:79], v8 offset:3168
    s_waitcnt lgkmcnt(13)
    v_mfma_f32_16x16x32_bf16 v[16:19], v[48:51], v[80:83], v[16:19]
    ds_read_b64 v[48:49], v6 offset:4608
    ds_read_b64 v[50:51], v7 offset:4608
    s_waitcnt lgkmcnt(13)
    v_mfma_f32_16x16x32_bf16 v[20:23], v[52:55], v[80:83], v[20:23]
    ds_read_b128 v[80:83], v8 offset:3680
    s_waitcnt lgkmcnt(13)
    v_mfma_f32_16x16x32_bf16 v[16:19], v[52:55], v[84:87], v[16:19]
    ds_read_b64 v[52:53], v6 offset:6656
    ds_read_b64 v[54:55], v7 offset:6656
    v_mfma_f32_16x16x32_bf16 v[20:23], v[228:231], v[84:87], v[20:23]
    ds_read_b128 v[84:87], v8 offset:4192
    s_waitcnt lgkmcnt(15)
    v_mfma_f32_16x16x32_bf16 v[16:19], v[232:235], v[56:59], v[16:19]
    v_mfma_f32_16x16x32_bf16 v[20:23], v[200:203], v[56:59], v[20:23]
    ds_read_b128 v[56:59], v8 offset:4768
    s_waitcnt lgkmcnt(15)
    v_mfma_f32_16x16x32_bf16 v[16:19], v[200:203], v[60:63], v[16:19]
    v_mfma_f32_16x16x32_bf16 v[20:23], v[168:171], v[60:63], v[20:23]
    ds_read_b128 v[60:63], v8 offset:5280
    s_waitcnt lgkmcnt(15)
    v_mfma_f32_16x16x32_bf16 v[16:19], v[168:171], v[64:67], v[16:19]
    v_mfma_f32_16x16x32_bf16 v[20:23], v[136:139], v[64:67], v[20:23]
    ds_read_b128 v[64:67], v8 offset:5792
    s_waitcnt lgkmcnt(13)
    v_mfma_f32_16x16x32_bf16 v[20:23], v[40:43], v[68:71], v[20:23]
    ds_read_b64 v[68:69], v4 offset:768
    ds_read_b64 v[70:71], v5 offset:768
    s_waitcnt lgkmcnt(14)
    v_mfma_f32_16x16x32_bf16 v[16:19], v[40:43], v[72:75], v[16:19]
    ds_read_b128 v[40:43], v8 offset:2208
    s_waitcnt lgkmcnt(13)
    v_mfma_f32_16x16x32_bf16 v[20:23], v[44:47], v[72:75], v[20:23]
    ds_read_b128 v[72:75], v8 offset:2720
    s_waitcnt lgkmcnt(13)
    v_mfma_f32_16x16x32_bf16 v[16:19], v[44:47], v[76:79], v[16:19]
    ds_read_b64 v[44:45], v4 offset:2816
    ds_read_b64 v[46:47], v5 offset:2816
    s_waitcnt lgkmcnt(13)
    v_mfma_f32_16x16x32_bf16 v[20:23], v[48:51], v[76:79], v[20:23]
    ds_read_b128 v[76:79], v8 offset:3232
    s_waitcnt lgkmcnt(13)
    v_mfma_f32_16x16x32_bf16 v[16:19], v[48:51], v[80:83], v[16:19]
    ds_read_b64 v[48:49], v4 offset:4864
    ds_read_b64 v[50:51], v5 offset:4864
    s_waitcnt lgkmcnt(13)
    v_mfma_f32_16x16x32_bf16 v[20:23], v[52:55], v[80:83], v[20:23]
    ds_read_b128 v[80:83], v8 offset:3744
    s_waitcnt lgkmcnt(13)
    v_mfma_f32_16x16x32_bf16 v[16:19], v[52:55], v[84:87], v[16:19]
    ds_read_b64 v[52:53], v4 offset:6912
    ds_read_b64 v[54:55], v5 offset:6912
    v_mfma_f32_16x16x32_bf16 v[20:23], v[232:235], v[84:87], v[20:23]
    ds_read_b128 v[84:87], v8 offset:4256
    s_waitcnt lgkmcnt(15)
    v_mfma_f32_16x16x32_bf16 v[16:19], v[236:239], v[56:59], v[16:19]
    v_mfma_f32_16x16x32_bf16 v[20:23], v[204:207], v[56:59], v[20:23]
    ds_read_b128 v[56:59], v8 offset:4832
    s_waitcnt lgkmcnt(15)
    v_mfma_f32_16x16x32_bf16 v[16:19], v[204:207], v[60:63], v[16:19]
    v_mfma_f32_16x16x32_bf16 v[20:23], v[172:175], v[60:63], v[20:23]
    ds_read_b128 v[60:63], v8 offset:5344
    s_waitcnt lgkmcnt(15)
    v_mfma_f32_16x16x32_bf16 v[16:19], v[172:175], v[64:67], v[16:19]
    v_mfma_f32_16x16x32_bf16 v[20:23], v[140:143], v[64:67], v[20:23]
    ds_read_b128 v[64:67], v8 offset:5856
    s_waitcnt lgkmcnt(13)
    v_mfma_f32_16x16x32_bf16 v[20:23], v[68:71], v[40:43], v[20:23]
    ds_read_b64 v[40:41], v6 offset:1024
    ds_read_b64 v[42:43], v7 offset:1024
    s_waitcnt lgkmcnt(14)
    v_mfma_f32_16x16x32_bf16 v[16:19], v[68:71], v[72:75], v[16:19]
    ds_read_b128 v[68:71], v8 offset:2272
    s_waitcnt lgkmcnt(13)
    v_mfma_f32_16x16x32_bf16 v[20:23], v[44:47], v[72:75], v[20:23]
    ds_read_b128 v[72:75], v8 offset:2784
    s_waitcnt lgkmcnt(13)
    v_mfma_f32_16x16x32_bf16 v[16:19], v[44:47], v[76:79], v[16:19]
    ds_read_b64 v[44:45], v6 offset:3072
    ds_read_b64 v[46:47], v7 offset:3072
    s_waitcnt lgkmcnt(13)
    v_mfma_f32_16x16x32_bf16 v[20:23], v[48:51], v[76:79], v[20:23]
    ds_read_b128 v[76:79], v8 offset:3296
    s_waitcnt lgkmcnt(13)
    v_mfma_f32_16x16x32_bf16 v[16:19], v[48:51], v[80:83], v[16:19]
    ds_read_b64 v[48:49], v6 offset:5120
    ds_read_b64 v[50:51], v7 offset:5120
    s_waitcnt lgkmcnt(13)
    v_mfma_f32_16x16x32_bf16 v[20:23], v[52:55], v[80:83], v[20:23]
    ds_read_b128 v[80:83], v8 offset:3808
    s_waitcnt lgkmcnt(13)
    v_mfma_f32_16x16x32_bf16 v[16:19], v[52:55], v[84:87], v[16:19]
    ds_read_b64 v[52:53], v6 offset:7168
    ds_read_b64 v[54:55], v7 offset:7168
    v_mfma_f32_16x16x32_bf16 v[20:23], v[236:239], v[84:87], v[20:23]
    ds_read_b128 v[84:87], v8 offset:4320
    s_setprio 2
    s_waitcnt lgkmcnt(15)
    v_mfma_f32_16x16x32_bf16 v[16:19], v[240:243], v[56:59], v[16:19]
    v_mfma_f32_16x16x32_bf16 v[20:23], v[208:211], v[56:59], v[20:23]
    ds_read_b128 v[56:59], v8 offset:4896
    s_waitcnt lgkmcnt(15)
    v_mfma_f32_16x16x32_bf16 v[16:19], v[208:211], v[60:63], v[16:19]
    v_mfma_f32_16x16x32_bf16 v[20:23], v[176:179], v[60:63], v[20:23]
    ds_read_b128 v[60:63], v8 offset:5408
    s_waitcnt lgkmcnt(15)
    v_mfma_f32_16x16x32_bf16 v[16:19], v[176:179], v[64:67], v[16:19]
    v_mfma_f32_16x16x32_bf16 v[20:23], v[144:147], v[64:67], v[20:23]
    ds_read_b128 v[64:67], v8 offset:5920
    s_waitcnt lgkmcnt(13)
    v_mfma_f32_16x16x32_bf16 v[20:23], v[40:43], v[68:71], v[20:23]
    ds_read_b64 v[68:69], v4 offset:1280
    ds_read_b64 v[70:71], v5 offset:1280
    s_waitcnt lgkmcnt(14)
    v_mfma_f32_16x16x32_bf16 v[16:19], v[40:43], v[72:75], v[16:19]
    ds_read_b128 v[40:43], v8 offset:2336
    s_waitcnt lgkmcnt(13)
    v_mfma_f32_16x16x32_bf16 v[20:23], v[44:47], v[72:75], v[20:23]
    ds_read_b128 v[72:75], v8 offset:2848
    s_waitcnt lgkmcnt(13)
    v_mfma_f32_16x16x32_bf16 v[16:19], v[44:47], v[76:79], v[16:19]
    ds_read_b64 v[44:45], v4 offset:3328
    ds_read_b64 v[46:47], v5 offset:3328
    s_waitcnt lgkmcnt(13)
    v_mfma_f32_16x16x32_bf16 v[20:23], v[48:51], v[76:79], v[20:23]
    ds_read_b128 v[76:79], v8 offset:3360
    s_waitcnt lgkmcnt(13)
    v_mfma_f32_16x16x32_bf16 v[16:19], v[48:51], v[80:83], v[16:19]
    ds_read_b64 v[48:49], v4 offset:5376
    ds_read_b64 v[50:51], v5 offset:5376
    s_waitcnt lgkmcnt(13)
    v_mfma_f32_16x16x32_bf16 v[20:23], v[52:55], v[80:83], v[20:23]
    ds_read_b128 v[80:83], v8 offset:3872
    global_load_dwordx4 v[100:103], v14, s[8:9]
    s_waitcnt lgkmcnt(13)
    v_mfma_f32_16x16x32_bf16 v[16:19], v[52:55], v[84:87], v[16:19]
    ds_read_b64 v[52:53], v4 offset:7424
    ds_read_b64 v[54:55], v5 offset:7424
    v_mfma_f32_16x16x32_bf16 v[20:23], v[240:243], v[84:87], v[20:23]
    ds_read_b128 v[84:87], v8 offset:4384
    s_waitcnt lgkmcnt(15)
    v_mfma_f32_16x16x32_bf16 v[16:19], v[244:247], v[56:59], v[16:19]
    v_mfma_f32_16x16x32_bf16 v[20:23], v[212:215], v[56:59], v[20:23]
    ds_read_b128 v[56:59], v8 offset:4960
    s_waitcnt lgkmcnt(15)
    v_mfma_f32_16x16x32_bf16 v[16:19], v[212:215], v[60:63], v[16:19]
    v_mfma_f32_16x16x32_bf16 v[20:23], v[180:183], v[60:63], v[20:23]
    ds_read_b128 v[60:63], v8 offset:5472
    s_waitcnt lgkmcnt(15)
    v_mfma_f32_16x16x32_bf16 v[16:19], v[180:183], v[64:67], v[16:19]
    v_mfma_f32_16x16x32_bf16 v[20:23], v[148:151], v[64:67], v[20:23]
    ds_read_b128 v[64:67], v8 offset:5984
    s_waitcnt lgkmcnt(13)
    v_mfma_f32_16x16x32_bf16 v[20:23], v[68:71], v[40:43], v[20:23]
    ds_read_b64 v[40:41], v6 offset:1536
    ds_read_b64 v[42:43], v7 offset:1536
    s_waitcnt lgkmcnt(14)
    v_mfma_f32_16x16x32_bf16 v[16:19], v[68:71], v[72:75], v[16:19]
    ds_read_b128 v[68:71], v8 offset:2400
    s_waitcnt lgkmcnt(13)
    v_mfma_f32_16x16x32_bf16 v[20:23], v[44:47], v[72:75], v[20:23]
    ds_read_b128 v[72:75], v8 offset:2912
    s_waitcnt lgkmcnt(13)
    v_mfma_f32_16x16x32_bf16 v[16:19], v[44:47], v[76:79], v[16:19]
    ds_read_b64 v[44:45], v6 offset:3584
    ds_read_b64 v[46:47], v7 offset:3584
    s_waitcnt lgkmcnt(13)
    v_mfma_f32_16x16x32_bf16 v[20:23], v[48:51], v[76:79], v[20:23]
    ds_read_b128 v[76:79], v8 offset:3424
    s_waitcnt lgkmcnt(13)
    v_mfma_f32_16x16x32_bf16 v[16:19], v[48:51], v[80:83], v[16:19]
    ds_read_b64 v[48:49], v6 offset:5632
    ds_read_b64 v[50:51], v7 offset:5632
    s_waitcnt lgkmcnt(13)
    v_mfma_f32_16x16x32_bf16 v[20:23], v[52:55], v[80:83], v[20:23]
    ds_read_b128 v[80:83], v8 offset:3936
    s_waitcnt lgkmcnt(13)
    v_mfma_f32_16x16x32_bf16 v[16:19], v[52:55], v[84:87], v[16:19]
    ds_read_b64 v[52:53], v6 offset:7680
    ds_read_b64 v[54:55], v7 offset:7680
    v_mfma_f32_16x16x32_bf16 v[20:23], v[244:247], v[84:87], v[20:23]
    ds_read_b128 v[84:87], v8 offset:4448
    s_setprio 1
    s_waitcnt lgkmcnt(15)
    v_mfma_f32_16x16x32_bf16 v[16:19], v[248:251], v[56:59], v[16:19]
    v_mfma_f32_16x16x32_bf16 v[20:23], v[216:219], v[56:59], v[20:23]
    ds_read_b128 v[56:59], v8 offset:5024
    s_waitcnt lgkmcnt(15)
    v_mfma_f32_16x16x32_bf16 v[16:19], v[216:219], v[60:63], v[16:19]
    v_mfma_f32_16x16x32_bf16 v[20:23], v[184:187], v[60:63], v[20:23]
    ds_read_b128 v[60:63], v8 offset:5536
    s_waitcnt lgkmcnt(15)
    v_mfma_f32_16x16x32_bf16 v[16:19], v[184:187], v[64:67], v[16:19]
    v_mfma_f32_16x16x32_bf16 v[20:23], v[152:155], v[64:67], v[20:23]
    ds_read_b128 v[64:67], v8 offset:6048
    s_waitcnt lgkmcnt(13)
    v_mfma_f32_16x16x32_bf16 v[20:23], v[40:43], v[68:71], v[20:23]
    ds_read_b64 v[68:69], v4 offset:1792
    ds_read_b64 v[70:71], v5 offset:1792
    s_waitcnt lgkmcnt(14)
    v_mfma_f32_16x16x32_bf16 v[16:19], v[40:43], v[72:75], v[16:19]
    ds_read_b128 v[40:43], v8 offset:2464
    s_waitcnt lgkmcnt(13)
    v_mfma_f32_16x16x32_bf16 v[20:23], v[44:47], v[72:75], v[20:23]
    ds_read_b128 v[72:75], v8 offset:2976
    s_waitcnt lgkmcnt(13)
    v_mfma_f32_16x16x32_bf16 v[16:19], v[44:47], v[76:79], v[16:19]
    ds_read_b64 v[44:45], v4 offset:3840
    ds_read_b64 v[46:47], v5 offset:3840
    s_waitcnt lgkmcnt(13)
    v_mfma_f32_16x16x32_bf16 v[20:23], v[48:51], v[76:79], v[20:23]
    ds_read_b128 v[76:79], v8 offset:3488
    s_waitcnt lgkmcnt(13)
    v_mfma_f32_16x16x32_bf16 v[16:19], v[48:51], v[80:83], v[16:19]
    ds_read_b64 v[48:49], v4 offset:5888
    ds_read_b64 v[50:51], v5 offset:5888
    s_waitcnt lgkmcnt(13)
    v_mfma_f32_16x16x32_bf16 v[20:23], v[52:55], v[80:83], v[20:23]
    ds_read_b128 v[80:83], v8 offset:4000
    s_waitcnt lgkmcnt(13)
    v_mfma_f32_16x16x32_bf16 v[16:19], v[52:55], v[84:87], v[16:19]
    ds_read_b64 v[52:53], v4 offset:7936
    ds_read_b64 v[54:55], v5 offset:7936
    v_mfma_f32_16x16x32_bf16 v[20:23], v[248:251], v[84:87], v[20:23]
    ds_read_b128 v[84:87], v8 offset:4512
    s_setprio 0
    s_waitcnt lgkmcnt(15)
    v_mfma_f32_16x16x32_bf16 v[16:19], v[252:255], v[56:59], v[16:19]
    v_mfma_f32_16x16x32_bf16 v[20:23], v[220:223], v[56:59], v[20:23]
    s_waitcnt lgkmcnt(14)
    v_mfma_f32_16x16x32_bf16 v[16:19], v[220:223], v[60:63], v[16:19]
    v_mfma_f32_16x16x32_bf16 v[20:23], v[188:191], v[60:63], v[20:23]
    s_waitcnt lgkmcnt(13)
    v_mfma_f32_16x16x32_bf16 v[16:19], v[188:191], v[64:67], v[16:19]
    v_mfma_f32_16x16x32_bf16 v[20:23], v[156:159], v[64:67], v[20:23]
    s_waitcnt lgkmcnt(10)
    v_mfma_f32_16x16x32_bf16 v[20:23], v[68:71], v[40:43], v[20:23]
    s_waitcnt lgkmcnt(9)
    v_mfma_f32_16x16x32_bf16 v[16:19], v[68:71], v[72:75], v[16:19]
    s_waitcnt lgkmcnt(7)
    v_mfma_f32_16x16x32_bf16 v[20:23], v[44:47], v[72:75], v[20:23]
    s_waitcnt lgkmcnt(6)
    v_mfma_f32_16x16x32_bf16 v[16:19], v[44:47], v[76:79], v[16:19]
    s_waitcnt lgkmcnt(4)
    v_mfma_f32_16x16x32_bf16 v[20:23], v[48:51], v[76:79], v[20:23]
    s_waitcnt lgkmcnt(3)
    v_mfma_f32_16x16x32_bf16 v[16:19], v[48:51], v[80:83], v[16:19]
    s_waitcnt lgkmcnt(1)
    v_mfma_f32_16x16x32_bf16 v[20:23], v[52:55], v[80:83], v[20:23]
    s_waitcnt lgkmcnt(0)
    v_mfma_f32_16x16x32_bf16 v[16:19], v[52:55], v[84:87], v[16:19]
    v_mfma_f32_16x16x32_bf16 v[20:23], v[252:255], v[84:87], v[20:23]
    s_nop 6
    v_cvt_pk_bf16_f32 v40, v16, v17
    v_cvt_pk_bf16_f32 v41, v18, v19
    ds_write_b64 v9, v[40:41] offset:0
    v_cvt_pk_bf16_f32 v42, v20, v21
    v_cvt_pk_bf16_f32 v43, v22, v23
    ds_write_b64 v9, v[42:43] offset:768
    s_waitcnt lgkmcnt(0)
    s_barrier
    ds_read_b64_tr_b16 v[44:45], v10
    ds_read_b64_tr_b16 v[46:47], v11
    s_waitcnt vmcnt(0)
    v_lshlrev_b32 v56, 16, v100
    v_and_b32 v57, 0xffff0000, v100
    v_lshlrev_b32 v58, 16, v101
    v_and_b32 v59, 0xffff0000, v101
    v_lshlrev_b32 v60, 16, v102
    v_and_b32 v61, 0xffff0000, v102
    v_lshlrev_b32 v62, 16, v103
    v_and_b32 v63, 0xffff0000, v103
    s_waitcnt lgkmcnt(1)
    v_lshlrev_b32 v48, 16, v44
    v_and_b32 v49, 0xffff0000, v44
    v_pk_mul_f32 v[48:49], v[48:49], v[56:57]
    v_cvt_pk_bf16_f32 v52, v48, v49
    v_lshlrev_b32 v50, 16, v45
    v_and_b32 v51, 0xffff0000, v45
    v_pk_mul_f32 v[50:51], v[50:51], v[58:59]
    v_cvt_pk_bf16_f32 v53, v50, v51
    s_waitcnt lgkmcnt(0)
    v_lshlrev_b32 v48, 16, v46
    v_and_b32 v49, 0xffff0000, v46
    v_pk_mul_f32 v[48:49], v[48:49], v[60:61]
    v_cvt_pk_bf16_f32 v54, v48, v49
    v_lshlrev_b32 v50, 16, v47
    v_and_b32 v51, 0xffff0000, v47
    v_pk_mul_f32 v[50:51], v[50:51], v[62:63]
    v_cvt_pk_bf16_f32 v55, v50, v51
    global_store_dwordx4 v15, v[52:55], s[30:31]
    s_branch L_fin
L_aq:
    global_load_dwordx4 v[52:55], v9, s[16:17] offset:2048 nt
    s_waitcnt lgkmcnt(0)
    s_mul_i32 s28, s28, 0x9e3779b1
    s_add_u32 s28, s28, 0x7f4a7c15
    s_mul_i32 s29, s29, 0x85ebca6d
    s_add_u32 s29, s29, 0x165667b1
    s_lshl_b32 s48, s76, 4
    v_bfe_u32 v123, v1, 2, 2
    v_mul_u32_u24 v10, 17200, v123
    v_and_b32 v124, 3, v1
    s_add_u32 s61, s60, 8192
    s_add_u32 s62, s60, 16384
    s_add_u32 s63, s60, 24576
    s_lshl_b32 s49, s6, 6
    s_add_u32 s49, s49, 1024
    v_add_u32 v123, s49, v1
    v_mul_u32_u24 v14, 1152, v123
    v_add_u32 v14, s48, v14
    v_mul_u32_u24 v15, 2304, v123
    v_add_u32 v15, s48, v15
    v_mul_u32_u24 v9, 192, v3
    v_lshl_add_u32 v9, v2, 3, v9
    v_add_u32 v9, s55, v9
    v_mul_u32_u24 v124, 192, v124
    v_lshl_add_u32 v124, v3, 3, v124
    s_lshr_b32 s49, s6, 2
    s_mul_i32 s49, s49, 768
    s_and_b32 s52, s6, 3
    s_lshl_b32 s52, s52, 5
    s_add_u32 s49, s49, s52
    v_add3_u32 v10, v10, v124, s49
    v_add_u32 v11, 68800, v10
    s_bitcmp1_b32 s50, 0
    s_cselect_b32 s52, 16, 0
    v_lshl_add_u32 v123, v3, 3, v2
    v_sub_u32 v123, 15, v123
    v_and_b32 v124, 1, v123
    v_lshlrev_b32 v124, 4, v124
    v_ashrrev_i32 v123, 1, v123
    s_lshr_b32 s53, s53, s52
    s_and_b32 s53, s53, 0xffff
    v_lshlrev_b32 v125, v124, s53
    v_cmp_eq_u32 vcc, 0, v123
    s_nop 1
    v_cndmask_b32 v88, 0, v125, vcc
    v_cmp_eq_u32 vcc, 1, v123
    s_nop 1
    v_cndmask_b32 v89, 0, v125, vcc
    v_cmp_eq_u32 vcc, 2, v123
    s_nop 1
    v_cndmask_b32 v90, 0, v125, vcc
    v_cmp_eq_u32 vcc, 3, v123
    s_nop 1
    v_cndmask_b32 v91, 0, v125, vcc
    s_waitcnt vmcnt(4)
    v_readfirstlane_b32 s66, v46
    v_readfirstlane_b32 s67, v47
    v_mov_b32 v64, v41
    v_mov_b32 v65, v42
    v_mov_b32 v66, v43
    v_mov_b32 v44, s66
    v_mov_b32 v45, s67
    v_alignbit_b32 v68, v41, v40, 16
    v_alignbit_b32 v69, v42, v41, 16
    v_alignbit_b32 v70, v43, v42, 16
    v_mov_b32_dpp v44, v40 wave_shl:1 row_mask:0xf bank_mask:0xf
    v_mov_b32_dpp v45, v41 wave_shl:1 row_mask:0xf bank_mask:0xf
    ds_write_b128 v118, v[42:45] offset:448
    v_mov_b32 v67, v44
    ds_write_b128 v118, v[64:67] offset:320
    v_alignbit_b32 v71, v44, v43, 16
    ds_write_b128 v117, v[68:71] offset:256
    v_mov_b32 v72, v69
    v_mov_b32 v73, v70
    v_mov_b32 v74, v71
    v_alignbit_b32 v75, v45, v44, 16
    ds_write_b128 v117, v[72:75] offset:384
    v_readfirstlane_b32 s66, v40
    v_readfirstlane_b32 s67, v41
    s_nop 1
    v_lshlrev_b64 v[96:97], v121, s[66:67]
    v_cndmask_b32_e64 v96, 0, v96, s[68:69]
    v_cndmask_b32_e64 v97, 0, v97, s[68:69]
    ds_write_b64 v120, v[96:97] offset:32
    s_mov_b32 s75, 0
    s_waitcnt vmcnt(1)
    v_mov_b32 v126, 137600
    v_mov_b32 v127, 1
    s_mov_b64 exec, 1
    ds_add_rtn_u32 v126, v126, v127
    s_waitcnt lgkmcnt(0)
    v_cmp_eq_u32 vcc, 7, v126
    s_nop 0
    s_cbranch_vccz Lpub_6
    s_lshl_b32 s49, s2, 7
    s_add_u32 s49, s49, 5242880
    v_mov_b32 v125, s49
    v_mov_b32 v126, s28
    v_mov_b32 v127, s29
    global_store_dwordx2 v125, v[126:127], s[34:35]
    v_add_u32 v125, 32768, v125
    global_store_dwordx2 v125, v[126:127], s[34:35] sc1
Lpub_6d:
    s_mov_b32 s75, 1
Lpub_6:
    s_mov_b64 exec, -1
    s_cmp_eq_u32 s75, 1
    s_waitcnt vmcnt(2)
    s_cbranch_scc1 Lpub_6w
    s_waitcnt vmcnt(0)
Lpub_6w:
    v_mov_b32 v76, v53
    v_mov_b32 v77, v54
    v_mov_b32 v78, v55
    v_alignbit_b32 v80, v53, v52, 16
    v_alignbit_b32 v81, v54, v53, 16
    v_alignbit_b32 v82, v55, v54, 16
    v_mov_b32_dpp v56, v52 wave_shl:1 row_mask:0xf bank_mask:0xf
    v_mov_b32_dpp v57, v53 wave_shl:1 row_mask:0xf bank_mask:0xf
    ds_write_b128 v118, v[54:57] offset:8640
    v_mov_b32 v79, v56
    ds_write_b128 v118, v[76:79] offset:8512
    v_alignbit_b32 v83, v56, v55, 16
    ds_write_b128 v117, v[80:83] offset:8448
    v_mov_b32 v84, v81
    v_mov_b32 v85, v82
    v_mov_b32 v86, v83
    v_alignbit_b32 v87, v57, v56, 16
    ds_write_b128 v117, v[84:87] offset:8576
    v_readfirstlane_b32 s66, v52
    v_readfirstlane_b32 s67, v53
    v_mov_b32 v64, v47
    v_mov_b32 v65, v48
    v_mov_b32 v66, v49
    v_mov_b32 v50, s66
    v_mov_b32 v51, s67
    v_alignbit_b32 v68, v47, v46, 16
    v_alignbit_b32 v69, v48, v47, 16
    v_alignbit_b32 v70, v49, v48, 16
    v_mov_b32_dpp v50, v46 wave_shl:1 row_mask:0xf bank_mask:0xf
    v_mov_b32_dpp v51, v47 wave_shl:1 row_mask:0xf bank_mask:0xf
    ds_write_b128 v118, v[48:51] offset:4544
    v_mov_b32 v67, v50
    ds_write_b128 v118, v[64:67] offset:4416
    v_alignbit_b32 v71, v50, v49, 16
    ds_write_b128 v117, v[68:71] offset:4352
    v_mov_b32 v72, v69
    v_mov_b32 v73, v70
    v_mov_b32 v74, v71
    v_alignbit_b32 v75, v51, v50, 16
    ds_write_b128 v117, v[72:75] offset:4480
    s_and_b32 s49, s76, 7
    s_mul_i32 s49, s49, 96
    s_mul_i32 s52, s6, 12
    s_add_u32 s49, s49, s52
    s_add_u32 s49, s49, 768
    s_mul_i32 s49, s49, 1152
    s_lshr_b32 s52, s76, 3
    s_lshl_b32 s52, s52, 7
    s_add_u32 s49, s49, s52
    v_lshrrev_b32 v123, 3, v1
    v_mul_u32_u24 v123, 1152, v123
    v_and_b32 v124, 7, v1
    v_lshl_add_u32 v123, v124, 4, v123
    v_add_u32 v125, s49, v123
    buffer_load_dwordx2 v[126:127], v122, s[56:59], s64 offen sc1
    s_waitcnt lgkmcnt(0)
    s_mov_b32 s49, 0
    s_branch Lpc_9
Lp_7:
    s_and_b32 s52, s49, 15
    s_cmp_eq_u32 s52, 15
    s_cselect_b32 s52, 32768, s64
    buffer_load_dwordx2 v[126:127], v122, s[56:59], s52 offen sc1
Lpc_9:
    s_add_u32 s49, s49, 1
    s_cmp_gt_u32 s49, 0x100000
    s_waitcnt vmcnt(0)
    v_cmp_ne_u64 vcc, s[28:29], v[126:127]
    s_cbranch_scc1 Lpx_8
    s_cbranch_vccnz Lp_7
Lpx_8:
Lpub_6f:
    buffer_load_dwordx4 v[100:103], v12, s[56:59], s60 offen sc1
    buffer_load_dwordx4 v[104:107], v12, s[56:59], s61 offen sc1
    buffer_load_dwordx4 v[108:111], v12, s[56:59], s62 offen sc1
    ds_read_b64 v[128:129], v6 offset:0
    ds_read_b64 v[130:131], v7 offset:0
    ds_read_b64 v[132:133], v4 offset:256
    ds_read_b64 v[134:135], v5 offset:256
    ds_read_b64 v[136:137], v6 offset:512
    ds_read_b64 v[138:139], v7 offset:512
    ds_read_b64 v[140:141], v4 offset:768
    ds_read_b64 v[142:143], v5 offset:768
    ds_read_b64 v[144:145], v6 offset:1024
    ds_read_b64 v[146:147], v7 offset:1024
    ds_read_b64 v[148:149], v4 offset:1280
    ds_read_b64 v[150:151], v5 offset:1280
    ds_read_b64 v[152:153], v6 offset:1536
    ds_read_b64 v[154:155], v7 offset:1536
    ds_read_b64 v[156:157], v4 offset:1792
    ds_read_b64 v[158:159], v5 offset:1792
    ds_read_b64 v[160:161], v6 offset:2048
    ds_read_b64 v[162:163], v7 offset:2048
    ds_read_b64 v[164:165], v4 offset:2304
    ds_read_b64 v[166:167], v5 offset:2304
    ds_read_b64 v[168:169], v6 offset:2560
    ds_read_b64 v[170:171], v7 offset:2560
    ds_read_b64 v[172:173], v4 offset:2816
    ds_read_b64 v[174:175], v5 offset:2816
    ds_read_b64 v[176:177], v6 offset:3072
    ds_read_b64 v[178:179], v7 offset:3072
    ds_read_b64 v[180:181], v4 offset:3328
    ds_read_b64 v[182:183], v5 offset:3328
    ds_read_b64 v[184:185], v6 offset:3584
    ds_read_b64 v[186:187], v7 offset:3584
    ds_read_b64 v[188:189], v4 offset:3840
    ds_read_b64 v[190:191], v5 offset:3840
    ds_read_b64 v[192:193], v6 offset:4096
    ds_read_b64 v[194:195], v7 offset:4096
    ds_read_b64 v[196:197], v4 offset:4352
    ds_read_b64 v[198:199], v5 offset:4352
    ds_read_b64 v[200:201], v6 offset:4608
    ds_read_b64 v[202:203], v7 offset:4608
    ds_read_b64 v[204:205], v4 offset:4864
    ds_read_b64 v[206:207], v5 offset:4864
    ds_read_b64 v[208:209], v6 offset:5120
    ds_read_b64 v[210:211], v7 offset:5120
    ds_read_b64 v[212:213], v4 offset:5376
    ds_read_b64 v[214:215], v5 offset:5376
    ds_read_b64 v[216:217], v6 offset:5632
    ds_read_b64 v[218:219], v7 offset:5632
    ds_read_b64 v[220:221], v4 offset:5888
    ds_read_b64 v[222:223], v5 offset:5888
    ds_read_b64 v[224:225], v6 offset:6144
    ds_read_b64 v[226:227], v7 offset:6144
    ds_read_b64 v[228:229], v4 offset:6400
    ds_read_b64 v[230:231], v5 offset:6400
    ds_read_b64 v[232:233], v6 offset:6656
    ds_read_b64 v[234:235], v7 offset:6656
    ds_read_b64 v[236:237], v4 offset:6912
    ds_read_b64 v[238:239], v5 offset:6912
    ds_read_b64 v[240:241], v6 offset:7168
    ds_read_b64 v[242:243], v7 offset:7168
    ds_read_b64 v[244:245], v4 offset:7424
    ds_read_b64 v[246:247], v5 offset:7424
    ds_read_b64 v[248:249], v6 offset:7680
    ds_read_b64 v[250:251], v7 offset:7680
    ds_read_b64 v[252:253], v4 offset:7936
    ds_read_b64 v[254:255], v5 offset:7936
    s_waitcnt vmcnt(2)
    ds_write_b128 v13, v[100:103] offset:3072
    s_waitcnt vmcnt(1)
    ds_write_b128 v13, v[104:107] offset:2048
    s_waitcnt vmcnt(0)
    ds_write_b128 v13, v[108:111] offset:1024
    s_waitcnt lgkmcnt(0)
    s_barrier
    global_load_dwordx4 v[100:103], v125, s[8:9] nt
    v_add_u32 v125, 4608, v125
    global_load_dwordx4 v[100:103], v125, s[8:9] nt
    s_cmp_lt_u32 s76, 64
    s_cbranch_scc1 Lc8_10
    s_bitcmp1_b32 s76, 2
    s_cselect_b32 s49, 0, 884736
    s_sub_u32 s49, s49, 442368
    v_add_u32 v125, s49, v125
    global_load_dwordx4 v[100:103], v125, s[8:9] nt
    v_add_u32 v125, 4294962688, v125
    global_load_dwordx4 v[100:103], v125, s[8:9] nt
Lc8_10:
    ds_read_b128 v[40:43], v8 offset:4064
    ds_read_b128 v[44:47], v8 offset:4576
    ds_read_b128 v[48:51], v8 offset:5088
    ds_read_b128 v[52:55], v8 offset:5600
    ds_read_b128 v[56:59], v8 offset:4128
    ds_read_b128 v[60:63], v8 offset:4640
    ds_read_b128 v[64:67], v8 offset:5152
    ds_read_b128 v[68:71], v8 offset:5664
    ds_read_b128 v[72:75], v8 offset:4192
    ds_read_b128 v[76:79], v8 offset:4704
    ds_read_b128 v[80:83], v8 offset:5216
    ds_read_b128 v[84:87], v8 offset:5728
    s_waitcnt lgkmcnt(11)
    v_mfma_f32_16x16x32_bf16 v[24:27], v[128:131], v[40:43], v[24:27]
    v_mfma_f32_16x16x32_bf16 v[24:27], v[88:91], v[40:43], v[24:27]
    ds_read_b128 v[40:43], v8 offset:4256
    s_waitcnt lgkmcnt(11)
    v_mfma_f32_16x16x32_bf16 v[24:27], v[160:163], v[44:47], v[24:27]
    ds_read_b128 v[44:47], v8 offset:4768
    s_waitcnt lgkmcnt(11)
    v_mfma_f32_16x16x32_bf16 v[24:27], v[192:195], v[48:51], v[24:27]
    ds_read_b128 v[48:51], v8 offset:5280
    s_waitcnt lgkmcnt(11)
    v_mfma_f32_16x16x32_bf16 v[24:27], v[224:227], v[52:55], v[24:27]
    ds_read_b128 v[52:55], v8 offset:5792
    s_waitcnt lgkmcnt(11)
    v_mfma_f32_16x16x32_bf16 v[24:27], v[132:135], v[56:59], v[24:27]
    ds_read_b128 v[56:59], v8 offset:4320
    s_waitcnt lgkmcnt(11)
    v_mfma_f32_16x16x32_bf16 v[24:27], v[164:167], v[60:63], v[24:27]
    ds_read_b128 v[60:63], v8 offset:4832
    s_waitcnt lgkmcnt(11)
    v_mfma_f32_16x16x32_bf16 v[24:27], v[196:199], v[64:67], v[24:27]
    ds_read_b128 v[64:67], v8 offset:5344
    s_waitcnt lgkmcnt(11)
    v_mfma_f32_16x16x32_bf16 v[24:27], v[228:231], v[68:71], v[24:27]
    ds_read_b128 v[68:71], v8 offset:5856
    s_waitcnt lgkmcnt(11)
    v_mfma_f32_16x16x32_bf16 v[24:27], v[136:139], v[72:75], v[24:27]
    ds_read_b128 v[72:75], v8 offset:4384
    s_waitcnt lgkmcnt(11)
    v_mfma_f32_16x16x32_bf16 v[24:27], v[168:171], v[76:79], v[24:27]
    ds_read_b128 v[76:79], v8 offset:4896
    s_waitcnt lgkmcnt(11)
    v_mfma_f32_16x16x32_bf16 v[24:27], v[200:203], v[80:83], v[24:27]
    ds_read_b128 v[80:83], v8 offset:5408
    s_waitcnt lgkmcnt(11)
    v_mfma_f32_16x16x32_bf16 v[24:27], v[232:235], v[84:87], v[24:27]
    ds_read_b128 v[84:87], v8 offset:5920
    s_waitcnt lgkmcnt(11)
    v_mfma_f32_16x16x32_bf16 v[24:27], v[140:143], v[40:43], v[24:27]
    ds_read_b128 v[40:43], v8 offset:4448
    s_waitcnt lgkmcnt(11)
    v_mfma_f32_16x16x32_bf16 v[24:27], v[172:175], v[44:47], v[24:27]
    ds_read_b128 v[44:47], v8 offset:4960
    s_waitcnt lgkmcnt(11)
    v_mfma_f32_16x16x32_bf16 v[24:27], v[204:207], v[48:51], v[24:27]
    ds_read_b128 v[48:51], v8 offset:5472
    s_waitcnt lgkmcnt(11)
    v_mfma_f32_16x16x32_bf16 v[24:27], v[236:239], v[52:55], v[24:27]
    ds_read_b128 v[52:55], v8 offset:5984
    s_waitcnt lgkmcnt(11)
    v_mfma_f32_16x16x32_bf16 v[24:27], v[144:147], v[56:59], v[24:27]
    ds_read_b128 v[56:59], v8 offset:4512
    s_waitcnt lgkmcnt(11)
    v_mfma_f32_16x16x32_bf16 v[24:27], v[176:179], v[60:63], v[24:27]
    ds_read_b128 v[60:63], v8 offset:5024
    s_waitcnt lgkmcnt(11)
    v_mfma_f32_16x16x32_bf16 v[24:27], v[208:211], v[64:67], v[24:27]
    ds_read_b128 v[64:67], v8 offset:5536
    s_waitcnt lgkmcnt(11)
    v_mfma_f32_16x16x32_bf16 v[24:27], v[240:243], v[68:71], v[24:27]
    ds_read_b128 v[68:71], v8 offset:6048
    s_waitcnt lgkmcnt(11)
    v_mfma_f32_16x16x32_bf16 v[24:27], v[148:151], v[72:75], v[24:27]
    ds_read_b128 v[72:75], v8 offset:3040
    s_waitcnt lgkmcnt(11)
    v_mfma_f32_16x16x32_bf16 v[24:27], v[180:183], v[76:79], v[24:27]
    ds_read_b128 v[76:79], v8 offset:3552
    s_waitcnt lgkmcnt(11)
    v_mfma_f32_16x16x32_bf16 v[24:27], v[212:215], v[80:83], v[24:27]
    ds_read_b128 v[80:83], v8 offset:4064
    s_waitcnt lgkmcnt(11)
    v_mfma_f32_16x16x32_bf16 v[24:27], v[244:247], v[84:87], v[24:27]
    ds_read_b128 v[84:87], v8 offset:4576
    s_waitcnt lgkmcnt(11)
    v_mfma_f32_16x16x32_bf16 v[24:27], v[152:155], v[40:43], v[24:27]
    ds_read_b128 v[40:43], v8 offset:5088
    s_waitcnt lgkmcnt(11)
    v_mfma_f32_16x16x32_bf16 v[24:27], v[184:187], v[44:47], v[24:27]
    ds_read_b64 v[44:45], v6 offset:8192
    ds_read_b64 v[46:47], v7 offset:8192
    s_waitcnt lgkmcnt(12)
    v_mfma_f32_16x16x32_bf16 v[24:27], v[216:219], v[48:51], v[24:27]
    ds_read_b128 v[48:51], v8 offset:5600
    s_waitcnt lgkmcnt(12)
    v_mfma_f32_16x16x32_bf16 v[24:27], v[248:251], v[52:55], v[24:27]
    ds_read_b64 v[52:53], v6 offset:10240
    ds_read_b64 v[54:55], v7 offset:10240
    s_waitcnt lgkmcnt(13)
    v_mfma_f32_16x16x32_bf16 v[24:27], v[156:159], v[56:59], v[24:27]
    ds_read_b128 v[56:59], v8 offset:3104
    s_waitcnt lgkmcnt(13)
    v_mfma_f32_16x16x32_bf16 v[24:27], v[188:191], v[60:63], v[24:27]
    ds_read_b128 v[60:63], v8 offset:3616
    s_waitcnt lgkmcnt(13)
    v_mfma_f32_16x16x32_bf16 v[24:27], v[220:223], v[64:67], v[24:27]
    ds_read_b128 v[64:67], v8 offset:4128
    s_waitcnt lgkmcnt(13)
    v_mfma_f32_16x16x32_bf16 v[24:27], v[252:255], v[68:71], v[24:27]
    ds_read_b128 v[68:71], v8 offset:4640
    s_setprio 3
    s_waitcnt lgkmcnt(13)
    v_mfma_f32_16x16x32_bf16 v[20:23], v[128:131], v[72:75], v[20:23]
    v_mfma_f32_16x16x32_bf16 v[20:23], v[88:91], v[72:75], v[20:23]
    ds_read_b128 v[72:75], v8 offset:5152
    s_waitcnt lgkmcnt(13)
    v_mfma_f32_16x16x32_bf16 v[16:19], v[128:131], v[76:79], v[16:19]
    v_mfma_f32_16x16x32_bf16 v[16:19], v[88:91], v[76:79], v[16:19]
    v_mfma_f32_16x16x32_bf16 v[20:23], v[160:163], v[76:79], v[20:23]
    ds_read_b64 v[76:77], v4 offset:8448
    ds_read_b64 v[78:79], v5 offset:8448
    v_cvt_pk_bf16_f32 v28, v24, v25
    v_cvt_pk_bf16_f32 v29, v26, v27
    ds_write_b64 v9, v[28:29] offset:2304
    s_waitcnt lgkmcnt(15)
    v_mfma_f32_16x16x32_bf16 v[16:19], v[160:163], v[80:83], v[16:19]
    v_mfma_f32_16x16x32_bf16 v[20:23], v[192:195], v[80:83], v[20:23]
    ds_read_b128 v[80:83], v8 offset:5664
    s_waitcnt lgkmcnt(15)
    v_mfma_f32_16x16x32_bf16 v[16:19], v[192:195], v[84:87], v[16:19]
    v_mfma_f32_16x16x32_bf16 v[20:23], v[224:227], v[84:87], v[20:23]
    ds_read_b64 v[84:85], v4 offset:10496
    ds_read_b64 v[86:87], v5 offset:10496
    s_waitcnt lgkmcnt(3)
    s_barrier
    v_mfma_f32_16x16x32_bf16 v[16:19], v[224:227], v[40:43], v[16:19]
    v_mfma_f32_16x16x32_bf16 v[20:23], v[44:47], v[40:43], v[20:23]
    ds_read_b128 v[40:43], v8 offset:3168
    v_mfma_f32_16x16x32_bf16 v[16:19], v[44:47], v[48:51], v[16:19]
    ds_read_b128 v[44:47], v8 offset:3680
    v_mfma_f32_16x16x32_bf16 v[20:23], v[52:55], v[48:51], v[20:23]
    ds_read_b128 v[48:51], v8 offset:4192
    ds_read_b128 v[52:55], v8 offset:4704
    v_mfma_f32_16x16x32_bf16 v[20:23], v[132:135], v[56:59], v[20:23]
    ds_read_b128 v[56:59], v8 offset:5216
    v_mfma_f32_16x16x32_bf16 v[16:19], v[132:135], v[60:63], v[16:19]
    s_cmp_lt_u32 s6, 4
    s_cbranch_scc1 Lmid_11
    v_add_u32 v123, 4294377472, v14
    global_load_dwordx4 v[104:107], v123, s[8:9]
    ds_read_b64_tr_b16 v[28:29], v10 offset:1536
    ds_read_b64_tr_b16 v[30:31], v11 offset:1536
Lmid_11:
    v_mfma_f32_16x16x32_bf16 v[20:23], v[164:167], v[60:63], v[20:23]
    ds_read_b64 v[60:61], v6 offset:8704
    ds_read_b64 v[62:63], v7 offset:8704
    v_mfma_f32_16x16x32_bf16 v[16:19], v[164:167], v[64:67], v[16:19]
    v_mfma_f32_16x16x32_bf16 v[20:23], v[196:199], v[64:67], v[20:23]
    ds_read_b128 v[64:67], v8 offset:5728
    v_mfma_f32_16x16x32_bf16 v[16:19], v[196:199], v[68:71], v[16:19]
    v_mfma_f32_16x16x32_bf16 v[20:23], v[228:231], v[68:71], v[20:23]
    ds_read_b64 v[68:69], v6 offset:10752
    ds_read_b64 v[70:71], v7 offset:10752
    v_mfma_f32_16x16x32_bf16 v[16:19], v[228:231], v[72:75], v[16:19]
    v_mfma_f32_16x16x32_bf16 v[20:23], v[76:79], v[72:75], v[20:23]
    ds_read_b128 v[72:75], v8 offset:3232
    s_waitcnt lgkmcnt(13)
    v_mfma_f32_16x16x32_bf16 v[16:19], v[76:79], v[80:83], v[16:19]
    ds_read_b128 v[76:79], v8 offset:3744
    s_waitcnt lgkmcnt(12)
    v_mfma_f32_16x16x32_bf16 v[20:23], v[84:87], v[80:83], v[20:23]
    ds_read_b128 v[80:83], v8 offset:4256
    ds_read_b128 v[84:87], v8 offset:4768
    s_setprio 2
    s_waitcnt lgkmcnt(13)
    v_mfma_f32_16x16x32_bf16 v[20:23], v[136:139], v[40:43], v[20:23]
    ds_read_b128 v[40:43], v8 offset:5280
    s_waitcnt lgkmcnt(13)
    v_mfma_f32_16x16x32_bf16 v[16:19], v[136:139], v[44:47], v[16:19]
    v_mfma_f32_16x16x32_bf16 v[20:23], v[168:171], v[44:47], v[20:23]
    ds_read_b64 v[44:45], v4 offset:8960
    ds_read_b64 v[46:47], v5 offset:8960
    s_waitcnt lgkmcnt(14)
    v_mfma_f32_16x16x32_bf16 v[16:19], v[168:171], v[48:51], v[16:19]
    v_mfma_f32_16x16x32_bf16 v[20:23], v[200:203], v[48:51], v[20:23]
    ds_read_b128 v[48:51], v8 offset:5792
    s_waitcnt lgkmcnt(14)
    v_mfma_f32_16x16x32_bf16 v[16:19], v[200:203], v[52:55], v[16:19]
    v_mfma_f32_16x16x32_bf16 v[20:23], v[232:235], v[52:55], v[20:23]
    ds_read_b64 v[52:53], v4 offset:11008
    ds_read_b64 v[54:55], v5 offset:11008
    s_waitcnt lgkmcnt(15)
    v_mfma_f32_16x16x32_bf16 v[16:19], v[232:235], v[56:59], v[16:19]
    s_waitcnt lgkmcnt(13)
    v_mfma_f32_16x16x32_bf16 v[20:23], v[60:63], v[56:59], v[20:23]
    ds_read_b128 v[56:59], v8 offset:3296
    s_waitcnt lgkmcnt(13)
    v_mfma_f32_16x16x32_bf16 v[16:19], v[60:63], v[64:67], v[16:19]
    ds_read_b128 v[60:63], v8 offset:3808
    s_waitcnt lgkmcnt(12)
    v_mfma_f32_16x16x32_bf16 v[20:23], v[68:71], v[64:67], v[20:23]
    ds_read_b128 v[64:67], v8 offset:4320
    ds_read_b128 v[68:71], v8 offset:4832
    s_waitcnt lgkmcnt(13)
    v_mfma_f32_16x16x32_bf16 v[20:23], v[140:143], v[72:75], v[20:23]
    ds_read_b128 v[72:75], v8 offset:5344
    s_waitcnt lgkmcnt(13)
    v_mfma_f32_16x16x32_bf16 v[16:19], v[140:143], v[76:79], v[16:19]
    v_mfma_f32_16x16x32_bf16 v[20:23], v[172:175], v[76:79], v[20:23]
    ds_read_b64 v[76:77], v6 offset:9216
    ds_read_b64 v[78:79], v7 offset:9216
    s_waitcnt lgkmcnt(14)
    v_mfma_f32_16x16x32_bf16 v[16:19], v[172:175], v[80:83], v[16:19]
    v_mfma_f32_16x16x32_bf16 v[20:23], v[204:207], v[80:83], v[20:23]
    ds_read_b128 v[80:83], v8 offset:5856
    s_waitcnt lgkmcnt(14)
    v_mfma_f32_16x16x32_bf16 v[16:19], v[204:207], v[84:87], v[16:19]
    v_mfma_f32_16x16x32_bf16 v[20:23], v[236:239], v[84:87], v[20:23]
    ds_read_b64 v[84:85], v6 offset:11264
    ds_read_b64 v[86:87], v7 offset:11264
    s_waitcnt lgkmcnt(15)
    v_mfma_f32_16x16x32_bf16 v[16:19], v[236:239], v[40:43], v[16:19]
    s_waitcnt lgkmcnt(13)
    v_mfma_f32_16x16x32_bf16 v[20:23], v[44:47], v[40:43], v[20:23]
    ds_read_b128 v[40:43], v8 offset:3360
    s_waitcnt lgkmcnt(13)
    v_mfma_f32_16x16x32_bf16 v[16:19], v[44:47], v[48:51], v[16:19]
    ds_read_b128 v[44:47], v8 offset:3872
    s_waitcnt lgkmcnt(12)
    v_mfma_f32_16x16x32_bf16 v[20:23], v[52:55], v[48:51], v[20:23]
    ds_read_b128 v[48:51], v8 offset:4384
    ds_read_b128 v[52:55], v8 offset:4896
    s_waitcnt lgkmcnt(13)
    v_mfma_f32_16x16x32_bf16 v[20:23], v[144:147], v[56:59], v[20:23]
    ds_read_b128 v[56:59], v8 offset:5408
    s_cmp_lt_u32 s6, 4
    s_cbranch_scc1 Lmid_12
    v_add_u32 v123, 4293787648, v15
    s_waitcnt vmcnt(0)
    v_lshlrev_b32 v32, 16, v28
    v_and_b32 v33, 0xffff0000, v28
    v_lshlrev_b32 v34, 16, v104
    v_and_b32 v35, 0xffff0000, v104
    v_pk_mul_f32 v[32:33], v[32:33], v[34:35]
    v_cvt_pk_bf16_f32 v36, v32, v33
    v_lshlrev_b32 v32, 16, v29
    v_and_b32 v33, 0xffff0000, v29
    v_lshlrev_b32 v34, 16, v105
    v_and_b32 v35, 0xffff0000, v105
    v_pk_mul_f32 v[32:33], v[32:33], v[34:35]
    v_cvt_pk_bf16_f32 v37, v32, v33
    v_lshlrev_b32 v32, 16, v30
    v_and_b32 v33, 0xffff0000, v30
    v_lshlrev_b32 v34, 16, v106
    v_and_b32 v35, 0xffff0000, v106
    v_pk_mul_f32 v[32:33], v[32:33], v[34:35]
    v_cvt_pk_bf16_f32 v38, v32, v33
    v_lshlrev_b32 v32, 16, v31
    v_and_b32 v33, 0xffff0000, v31
    v_lshlrev_b32 v34, 16, v107
    v_and_b32 v35, 0xffff0000, v107
    v_pk_mul_f32 v[32:33], v[32:33], v[34:35]
    v_cvt_pk_bf16_f32 v39, v32, v33
    global_store_dwordx4 v123, v[36:39], s[30:31]
Lmid_12:
    s_waitcnt lgkmcnt(13)
    v_mfma_f32_16x16x32_bf16 v[16:19], v[144:147], v[60:63], v[16:19]
    global_load_dwordx4 v[100:103], v14, s[8:9]
    v_mfma_f32_16x16x32_bf16 v[20:23], v[176:179], v[60:63], v[20:23]
    ds_read_b64 v[60:61], v4 offset:9472
    ds_read_b64 v[62:63], v5 offset:9472
    s_waitcnt lgkmcnt(14)
    v_mfma_f32_16x16x32_bf16 v[16:19], v[176:179], v[64:67], v[16:19]
    v_mfma_f32_16x16x32_bf16 v[20:23], v[208:211], v[64:67], v[20:23]
    ds_read_b128 v[64:67], v8 offset:5920
    s_waitcnt lgkmcnt(14)
    v_mfma_f32_16x16x32_bf16 v[16:19], v[208:211], v[68:71], v[16:19]
    v_mfma_f32_16x16x32_bf16 v[20:23], v[240:243], v[68:71], v[20:23]
    ds_read_b64 v[68:69], v4 offset:11520
    ds_read_b64 v[70:71], v5 offset:11520
    s_waitcnt lgkmcnt(15)
    v_mfma_f32_16x16x32_bf16 v[16:19], v[240:243], v[72:75], v[16:19]
    s_waitcnt lgkmcnt(13)
    v_mfma_f32_16x16x32_bf16 v[20:23], v[76:79], v[72:75], v[20:23]
    ds_read_b128 v[72:75], v8 offset:3424
    s_waitcnt lgkmcnt(13)
    v_mfma_f32_16x16x32_bf16 v[16:19], v[76:79], v[80:83], v[16:19]
    ds_read_b128 v[76:79], v8 offset:3936
    s_waitcnt lgkmcnt(12)
    v_mfma_f32_16x16x32_bf16 v[20:23], v[84:87], v[80:83], v[20:23]
    ds_read_b128 v[80:83], v8 offset:4448
    ds_read_b128 v[84:87], v8 offset:4960
    s_setprio 1
    s_waitcnt lgkmcnt(13)
    v_mfma_f32_16x16x32_bf16 v[20:23], v[148:151], v[40:43], v[20:23]
    ds_read_b128 v[40:43], v8 offset:5472
    s_waitcnt lgkmcnt(13)
    v_mfma_f32_16x16x32_bf16 v[16:19], v[148:151], v[44:47], v[16:19]
    v_mfma_f32_16x16x32_bf16 v[20:23], v[180:183], v[44:47], v[20:23]
    ds_read_b64 v[44:45], v6 offset:9728
    ds_read_b64 v[46:47], v7 offset:9728
    s_waitcnt lgkmcnt(14)
    v_mfma_f32_16x16x32_bf16 v[16:19], v[180:183], v[48:51], v[16:19]
    v_mfma_f32_16x16x32_bf16 v[20:23], v[212:215], v[48:51], v[20:23]
    ds_read_b128 v[48:51], v8 offset:5984
    s_waitcnt lgkmcnt(14)
    v_mfma_f32_16x16x32_bf16 v[16:19], v[212:215], v[52:55], v[16:19]
    v_mfma_f32_16x16x32_bf16 v[20:23], v[244:247], v[52:55], v[20:23]
    ds_read_b64 v[52:53], v6 offset:11776
    ds_read_b64 v[54:55], v7 offset:11776
    s_waitcnt lgkmcnt(15)
    v_mfma_f32_16x16x32_bf16 v[16:19], v[244:247], v[56:59], v[16:19]
    s_waitcnt lgkmcnt(13)
    v_mfma_f32_16x16x32_bf16 v[20:23], v[60:63], v[56:59], v[20:23]
    ds_read_b128 v[56:59], v8 offset:3488
    s_waitcnt lgkmcnt(13)
    v_mfma_f32_16x16x32_bf16 v[16:19], v[60:63], v[64:67], v[16:19]
    ds_read_b128 v[60:63], v8 offset:4000
    s_waitcnt lgkmcnt(12)
    v_mfma_f32_16x16x32_bf16 v[20:23], v[68:71], v[64:67], v[20:23]
    ds_read_b128 v[64:67], v8 offset:4512
    ds_read_b128 v[68:71], v8 offset:5024
    s_waitcnt lgkmcnt(13)
    v_mfma_f32_16x16x32_bf16 v[20:23], v[152:155], v[72:75], v[20:23]
    ds_read_b128 v[72:75], v8 offset:5536
    s_waitcnt lgkmcnt(13)
    v_mfma_f32_16x16x32_bf16 v[16:19], v[152:155], v[76:79], v[16:19]
    v_mfma_f32_16x16x32_bf16 v[20:23], v[184:187], v[76:79], v[20:23]
    ds_read_b64 v[76:77], v4 offset:9984
    ds_read_b64 v[78:79], v5 offset:9984
    s_waitcnt lgkmcnt(14)
    v_mfma_f32_16x16x32_bf16 v[16:19], v[184:187], v[80:83], v[16:19]
    v_mfma_f32_16x16x32_bf16 v[20:23], v[216:219], v[80:83], v[20:23]
    ds_read_b128 v[80:83], v8 offset:6048
    s_waitcnt lgkmcnt(14)
    v_mfma_f32_16x16x32_bf16 v[16:19], v[216:219], v[84:87], v[16:19]
    v_mfma_f32_16x16x32_bf16 v[20:23], v[248:251], v[84:87], v[20:23]
    ds_read_b64 v[84:85], v4 offset:12032
    ds_read_b64 v[86:87], v5 offset:12032
    s_waitcnt lgkmcnt(15)
    v_mfma_f32_16x16x32_bf16 v[16:19], v[248:251], v[40:43], v[16:19]
    s_waitcnt lgkmcnt(13)
    v_mfma_f32_16x16x32_bf16 v[20:23], v[44:47], v[40:43], v[20:23]
    s_waitcnt lgkmcnt(12)
    v_mfma_f32_16x16x32_bf16 v[16:19], v[44:47], v[48:51], v[16:19]
    s_waitcnt lgkmcnt(10)
    v_mfma_f32_16x16x32_bf16 v[20:23], v[52:55], v[48:51], v[20:23]
    s_setprio 0
    s_waitcnt lgkmcnt(9)
    v_mfma_f32_16x16x32_bf16 v[20:23], v[156:159], v[56:59], v[20:23]
    s_waitcnt lgkmcnt(8)
    v_mfma_f32_16x16x32_bf16 v[16:19], v[156:159], v[60:63], v[16:19]
    v_mfma_f32_16x16x32_bf16 v[20:23], v[188:191], v[60:63], v[20:23]
    s_waitcnt lgkmcnt(7)
    v_mfma_f32_16x16x32_bf16 v[16:19], v[188:191], v[64:67], v[16:19]
    v_mfma_f32_16x16x32_bf16 v[20:23], v[220:223], v[64:67], v[20:23]
    s_waitcnt lgkmcnt(6)
    v_mfma_f32_16x16x32_bf16 v[16:19], v[220:223], v[68:71], v[16:19]
    v_mfma_f32_16x16x32_bf16 v[20:23], v[252:255], v[68:71], v[20:23]
    s_waitcnt lgkmcnt(5)
    v_mfma_f32_16x16x32_bf16 v[16:19], v[252:255], v[72:75], v[16:19]
    s_waitcnt lgkmcnt(3)
    v_mfma_f32_16x16x32_bf16 v[20:23], v[76:79], v[72:75], v[20:23]
    s_waitcnt lgkmcnt(2)
    v_mfma_f32_16x16x32_bf16 v[16:19], v[76:79], v[80:83], v[16:19]
    s_waitcnt lgkmcnt(0)
    v_mfma_f32_16x16x32_bf16 v[20:23], v[84:87], v[80:83], v[20:23]
    s_nop 5
    v_cvt_pk_bf16_f32 v40, v16, v17
    v_cvt_pk_bf16_f32 v41, v18, v19
    ds_write_b64 v9, v[40:41] offset:0
    v_cvt_pk_bf16_f32 v42, v20, v21
    v_cvt_pk_bf16_f32 v43, v22, v23
    ds_write_b64 v9, v[42:43] offset:768
    s_waitcnt lgkmcnt(0)
    s_barrier
    ds_read_b64_tr_b16 v[44:45], v10
    ds_read_b64_tr_b16 v[46:47], v11
    s_waitcnt vmcnt(0)
    v_lshlrev_b32 v56, 16, v100
    v_and_b32 v57, 0xffff0000, v100
    v_lshlrev_b32 v58, 16, v101
    v_and_b32 v59, 0xffff0000, v101
    v_lshlrev_b32 v60, 16, v102
    v_and_b32 v61, 0xffff0000, v102
    v_lshlrev_b32 v62, 16, v103
    v_and_b32 v63, 0xffff0000, v103
    s_waitcnt lgkmcnt(1)
    v_lshlrev_b32 v48, 16, v44
    v_and_b32 v49, 0xffff0000, v44
    v_pk_mul_f32 v[48:49], v[48:49], v[56:57]
    v_cvt_pk_bf16_f32 v52, v48, v49
    v_lshlrev_b32 v50, 16, v45
    v_and_b32 v51, 0xffff0000, v45
    v_pk_mul_f32 v[50:51], v[50:51], v[58:59]
    v_cvt_pk_bf16_f32 v53, v50, v51
    s_waitcnt lgkmcnt(0)
    v_lshlrev_b32 v48, 16, v46
    v_and_b32 v49, 0xffff0000, v46
    v_pk_mul_f32 v[48:49], v[48:49], v[60:61]
    v_cvt_pk_bf16_f32 v54, v48, v49
    v_lshlrev_b32 v50, 16, v47
    v_and_b32 v51, 0xffff0000, v47
    v_pk_mul_f32 v[50:51], v[50:51], v[62:63]
    v_cvt_pk_bf16_f32 v55, v50, v51
    global_store_dwordx4 v15, v[52:55], s[30:31]
    s_branch L_fin
L_al:
    global_load_dwordx4 v[52:55], v9, s[16:17] offset:2048 nt
    s_waitcnt lgkmcnt(0)
    s_mul_i32 s28, s28, 0x9e3779b1
    s_add_u32 s28, s28, 0x7f4a7c15
    s_mul_i32 s29, s29, 0x85ebca6d
    s_add_u32 s29, s29, 0x165667b1
    s_lshl_b32 s48, s76, 4
    v_bfe_u32 v123, v1, 2, 2
    v_mul_u32_u24 v10, 17200, v123
    v_and_b32 v124, 3, v1
    s_cmp_ge_u32 s6, 4
    s_cselect_b32 s49, 20480, 0
    s_cselect_b32 s63, -480, 0
    s_add_u32 s61, s60, s49
    s_add_u32 s61, s61, 8192
    s_add_u32 s62, s60, 36864
    s_lshl_b32 s49, s6, 5
    v_lshrrev_b32 v123, 1, v1
    v_add_u32 v123, s49, v123
    v_and_b32 v125, 1, v1
    v_lshl_add_u32 v125, v125, 4, s48
    v_mul_u32_u24 v14, 1152, v123
    v_add_u32 v14, v125, v14
    v_mul_u32_u24 v15, 2304, v123
    v_add_u32 v15, v125, v15
    v_mul_u32_u24 v9, 320, v3
    v_lshl_add_u32 v9, v2, 4, v9
    v_add_u32 v9, s55, v9
    v_and_b32 v123, 1, v3
    v_lshlrev_b32 v123, 1, v123
    v_lshrrev_b32 v125, 1, v124
    v_add_u32 v123, v123, v125
    v_mul_u32_u24 v123, 320, v123
    v_and_b32 v124, 1, v124
    v_lshl_add_u32 v124, v124, 3, v123
    v_lshrrev_b32 v123, 1, v3
    v_lshl_add_u32 v124, v123, 4, v124
    s_lshl_b32 s49, s6, 5
    v_min_u32 v123, 464, v119
    v_add_u32 v123, s55, v123
    ds_write_b128 v123, v[16:19] offset:14624
    v_add3_u32 v10, v10, v124, s49
    v_add_u32 v11, 68800, v10
    s_bitcmp1_b32 s50, 0
    s_cselect_b32 s52, 16, 0
    v_lshl_add_u32 v123, v3, 3, v2
    v_sub_u32 v123, 15, v123
    v_and_b32 v124, 1, v123
    v_lshlrev_b32 v124, 4, v124
    v_ashrrev_i32 v123, 1, v123
    s_lshr_b32 s53, s53, s52
    s_and_b32 s53, s53, 0xffff
    v_lshlrev_b32 v125, v124, s53
    s_lshr_b32 s65, s65, s52
    s_and_b32 s65, s65, 0xffff
    v_lshlrev_b32 v124, v124, s65
    v_cmp_eq_u32 vcc, 0, v123
    s_nop 1
    v_cndmask_b32 v88, 0, v125, vcc
    v_cndmask_b32 v92, 0, v124, vcc
    v_cmp_eq_u32 vcc, 1, v123
    s_nop 1
    v_cndmask_b32 v89, 0, v125, vcc
    v_cndmask_b32 v93, 0, v124, vcc
    v_cmp_eq_u32 vcc, 2, v123
    s_nop 1
    v_cndmask_b32 v90, 0, v125, vcc
    v_cndmask_b32 v94, 0, v124, vcc
    v_cmp_eq_u32 vcc, 3, v123
    s_nop 1
    v_cndmask_b32 v91, 0, v125, vcc
    v_cndmask_b32 v95, 0, v124, vcc
    s_waitcnt vmcnt(4)
    v_readfirstlane_b32 s66, v46
    v_readfirstlane_b32 s67, v47
    v_mov_b32 v64, v41
    v_mov_b32 v65, v42
    v_mov_b32 v66, v43
    v_mov_b32 v44, s66
    v_mov_b32 v45, s67
    v_alignbit_b32 v68, v41, v40, 16
    v_alignbit_b32 v69, v42, v41, 16
    v_alignbit_b32 v70, v43, v42, 16
    v_mov_b32_dpp v44, v40 wave_shl:1 row_mask:0xf bank_mask:0xf
    v_mov_b32_dpp v45, v41 wave_shl:1 row_mask:0xf bank_mask:0xf
    ds_write_b128 v118, v[42:45] offset:448
    v_mov_b32 v67, v44
    ds_write_b128 v118, v[64:67] offset:320
    v_alignbit_b32 v71, v44, v43, 16
    ds_write_b128 v117, v[68:71] offset:256
    v_mov_b32 v72, v69
    v_mov_b32 v73, v70
    v_mov_b32 v74, v71
    v_alignbit_b32 v75, v45, v44, 16
    ds_write_b128 v117, v[72:75] offset:384
    v_readfirstlane_b32 s66, v40
    v_readfirstlane_b32 s67, v41
    s_nop 1
    v_lshlrev_b64 v[96:97], v121, s[66:67]
    v_cndmask_b32_e64 v96, 0, v96, s[68:69]
    v_cndmask_b32_e64 v97, 0, v97, s[68:69]
    ds_write_b64 v120, v[96:97] offset:32
    s_mov_b32 s75, 0
    s_waitcnt vmcnt(1)
    v_mov_b32 v126, 137600
    v_mov_b32 v127, 1
    s_mov_b64 exec, 1
    ds_add_rtn_u32 v126, v126, v127
    s_waitcnt lgkmcnt(0)
    v_cmp_eq_u32 vcc, 7, v126
    s_nop 0
    s_cbranch_vccz Lpub_13
    s_lshl_b32 s49, s2, 7
    s_add_u32 s49, s49, 5242880
    v_mov_b32 v125, s49
    v_mov_b32 v126, s28
    v_mov_b32 v127, s29
    global_store_dwordx2 v125, v[126:127], s[34:35]
    v_add_u32 v125, 32768, v125
    global_store_dwordx2 v125, v[126:127], s[34:35] sc1
Lpub_13d:
    s_mov_b32 s75, 1
Lpub_13:
    s_mov_b64 exec, -1
    s_cmp_eq_u32 s75, 1
    s_waitcnt vmcnt(2)
    s_cbranch_scc1 Lpub_13w
    s_waitcnt vmcnt(0)
Lpub_13w:
    v_mov_b32 v76, v53
    v_mov_b32 v77, v54
    v_mov_b32 v78, v55
    v_alignbit_b32 v80, v53, v52, 16
    v_alignbit_b32 v81, v54, v53, 16
    v_alignbit_b32 v82, v55, v54, 16
    v_mov_b32_dpp v56, v52 wave_shl:1 row_mask:0xf bank_mask:0xf
    v_mov_b32_dpp v57, v53 wave_shl:1 row_mask:0xf bank_mask:0xf
    ds_write_b128 v118, v[54:57] offset:9152
    v_mov_b32 v79, v56
    ds_write_b128 v118, v[76:79] offset:9024
    v_alignbit_b32 v83, v56, v55, 16
    ds_write_b128 v117, v[80:83] offset:8960
    v_mov_b32 v84, v81
    v_mov_b32 v85, v82
    v_mov_b32 v86, v83
    v_alignbit_b32 v87, v57, v56, 16
    ds_write_b128 v117, v[84:87] offset:9088
    v_readfirstlane_b32 s66, v52
    v_readfirstlane_b32 s67, v53
    v_and_b32 v123, 512, v119
    v_add_u32 v117, v117, v123
    v_add_u32 v118, v118, v123
    v_mov_b32 v64, v47
    v_mov_b32 v65, v48
    v_mov_b32 v66, v49
    v_mov_b32 v50, s66
    v_mov_b32 v51, s67
    v_alignbit_b32 v68, v47, v46, 16
    v_alignbit_b32 v69, v48, v47, 16
    v_alignbit_b32 v70, v49, v48, 16
    v_mov_b32_dpp v50, v46 wave_shl:1 row_mask:0xf bank_mask:0xf
    v_mov_b32_dpp v51, v47 wave_shl:1 row_mask:0xf bank_mask:0xf
    ds_write_b128 v118, v[48:51] offset:4544
    v_mov_b32 v67, v50
    ds_write_b128 v118, v[64:67] offset:4416
    v_alignbit_b32 v71, v50, v49, 16
    ds_write_b128 v117, v[68:71] offset:4352
    v_mov_b32 v72, v69
    v_mov_b32 v73, v70
    v_mov_b32 v74, v71
    v_alignbit_b32 v75, v51, v50, 16
    ds_write_b128 v117, v[72:75] offset:4480
    v_readlane_b32 s66, v46, 32
    v_readlane_b32 s67, v47, 32
    s_nop 1
    v_lshlrev_b64 v[98:99], v121, s[66:67]
    v_cndmask_b32_e64 v98, 0, v98, s[68:69]
    v_cndmask_b32_e64 v99, 0, v99, s[68:69]
    ds_write_b64 v120, v[98:99] offset:6688
    s_and_b32 s49, s76, 7
    s_mul_i32 s49, s49, 96
    s_mul_i32 s52, s6, 24
    s_add_u32 s49, s49, s52
    s_add_u32 s49, s49, 0
    s_mul_i32 s49, s49, 1152
    s_lshr_b32 s52, s76, 3
    s_lshl_b32 s52, s52, 7
    s_add_u32 s49, s49, s52
    v_lshrrev_b32 v123, 3, v1
    v_mul_u32_u24 v123, 1152, v123
    v_and_b32 v124, 7, v1
    v_lshl_add_u32 v123, v124, 4, v123
    v_add_u32 v125, s49, v123
    buffer_load_dwordx2 v[126:127], v122, s[56:59], s64 offen sc1
    s_waitcnt lgkmcnt(0)
    s_mov_b32 s49, 0
    s_branch Lpc_16
Lp_14:
    s_and_b32 s52, s49, 15
    s_cmp_eq_u32 s52, 15
    s_cselect_b32 s52, 32768, s64
    buffer_load_dwordx2 v[126:127], v122, s[56:59], s52 offen sc1
Lpc_16:
    s_add_u32 s49, s49, 1
    s_cmp_gt_u32 s49, 0x100000
    s_waitcnt vmcnt(0)
    v_cmp_ne_u64 vcc, s[28:29], v[126:127]
    s_cbranch_scc1 Lpx_15
    s_cbranch_vccnz Lp_14
Lpx_15:
Lpub_13f:
    buffer_load_dwordx4 v[100:103], v12, s[56:59], s60 offen sc1
    buffer_load_dwordx4 v[104:107], v12, s[56:59], s61 offen sc1
    buffer_load_dwordx4 v[108:111], v12, s[56:59], s62 offen sc1
    ds_read_b64 v[128:129], v6 offset:0
    ds_read_b64 v[130:131], v7 offset:0
    ds_read_b64 v[132:133], v4 offset:256
    ds_read_b64 v[134:135], v5 offset:256
    ds_read_b64 v[136:137], v6 offset:512
    ds_read_b64 v[138:139], v7 offset:512
    ds_read_b64 v[140:141], v4 offset:768
    ds_read_b64 v[142:143], v5 offset:768
    ds_read_b64 v[144:145], v6 offset:1024
    ds_read_b64 v[146:147], v7 offset:1024
    ds_read_b64 v[148:149], v4 offset:1280
    ds_read_b64 v[150:151], v5 offset:1280
    ds_read_b64 v[152:153], v6 offset:1536
    ds_read_b64 v[154:155], v7 offset:1536
    ds_read_b64 v[156:157], v4 offset:1792
    ds_read_b64 v[158:159], v5 offset:1792
    ds_read_b64 v[160:161], v6 offset:6656
    ds_read_b64 v[162:163], v7 offset:6656
    ds_read_b64 v[164:165], v4 offset:6912
    ds_read_b64 v[166:167], v5 offset:6912
    ds_read_b64 v[168:169], v6 offset:7168
    ds_read_b64 v[170:171], v7 offset:7168
    ds_read_b64 v[172:173], v4 offset:7424
    ds_read_b64 v[174:175], v5 offset:7424
    ds_read_b64 v[176:177], v6 offset:7680
    ds_read_b64 v[178:179], v7 offset:7680
    ds_read_b64 v[180:181], v4 offset:7936
    ds_read_b64 v[182:183], v5 offset:7936
    ds_read_b64 v[184:185], v6 offset:8192
    ds_read_b64 v[186:187], v7 offset:8192
    ds_read_b64 v[188:189], v4 offset:8448
    ds_read_b64 v[190:191], v5 offset:8448
    ds_read_b64 v[192:193], v6 offset:2048
    ds_read_b64 v[194:195], v7 offset:2048
    ds_read_b64 v[196:197], v4 offset:2304
    ds_read_b64 v[198:199], v5 offset:2304
    ds_read_b64 v[200:201], v6 offset:2560
    ds_read_b64 v[202:203], v7 offset:2560
    ds_read_b64 v[204:205], v4 offset:2816
    ds_read_b64 v[206:207], v5 offset:2816
    ds_read_b64 v[208:209], v6 offset:3072
    ds_read_b64 v[210:211], v7 offset:3072
    ds_read_b64 v[212:213], v4 offset:3328
    ds_read_b64 v[214:215], v5 offset:3328
    ds_read_b64 v[216:217], v6 offset:3584
    ds_read_b64 v[218:219], v7 offset:3584
    ds_read_b64 v[220:221], v4 offset:3840
    ds_read_b64 v[222:223], v5 offset:3840
    ds_read_b64 v[224:225], v6 offset:4096
    ds_read_b64 v[226:227], v7 offset:4096
    ds_read_b64 v[228:229], v4 offset:4352
    ds_read_b64 v[230:231], v5 offset:4352
    ds_read_b64 v[232:233], v6 offset:4608
    ds_read_b64 v[234:235], v7 offset:4608
    ds_read_b64 v[236:237], v4 offset:4864
    ds_read_b64 v[238:239], v5 offset:4864
    ds_read_b64 v[240:241], v6 offset:5120
    ds_read_b64 v[242:243], v7 offset:5120
    ds_read_b64 v[244:245], v4 offset:5376
    ds_read_b64 v[246:247], v5 offset:5376
    ds_read_b64 v[248:249], v6 offset:5632
    ds_read_b64 v[250:251], v7 offset:5632
    ds_read_b64 v[252:253], v4 offset:5888
    ds_read_b64 v[254:255], v5 offset:5888
    ds_read_b64 v[40:41], v6 offset:8704
    ds_read_b64 v[42:43], v7 offset:8704
    ds_read_b64 v[44:45], v6 offset:10752
    ds_read_b64 v[46:47], v7 offset:10752
    v_add_u32 v123, s63, v13
    s_waitcnt vmcnt(2)
    ds_write_b128 v13, v[100:103] offset:3072
    s_waitcnt vmcnt(1)
    ds_write_b128 v123, v[104:107] offset:2048
    s_waitcnt vmcnt(0)
    ds_write_b128 v13, v[108:111] offset:544
    s_waitcnt lgkmcnt(0)
    s_barrier
    global_load_dwordx4 v[100:103], v125, s[8:9] nt
    v_add_u32 v125, 9216, v125
    global_load_dwordx4 v[100:103], v125, s[8:9] nt
    v_add_u32 v125, 9216, v125
    global_load_dwordx4 v[100:103], v125, s[8:9] nt
    ds_read_b128 v[48:51], v8 offset:4576
    ds_read_b128 v[52:55], v8 offset:5088
    ds_read_b128 v[56:59], v8 offset:5600
    ds_read_b128 v[60:63], v8 offset:2560
    ds_read_b128 v[64:67], v8 offset:3072
    ds_read_b128 v[68:71], v8 offset:3584
    ds_read_b128 v[72:75], v8 offset:4640
    ds_read_b128 v[76:79], v8 offset:5152
    ds_read_b128 v[80:83], v8 offset:5664
    ds_read_b128 v[84:87], v8 offset:2624
    s_setprio 3
    s_waitcnt lgkmcnt(9)
    v_mfma_f32_16x16x32_bf16 v[32:35], v[128:131], v[48:51], v[32:35]
    v_mfma_f32_16x16x32_bf16 v[32:35], v[88:91], v[48:51], v[32:35]
    ds_read_b128 v[48:51], v8 offset:3136
    s_waitcnt lgkmcnt(9)
    v_mfma_f32_16x16x32_bf16 v[24:27], v[128:131], v[52:55], v[24:27]
    v_mfma_f32_16x16x32_bf16 v[24:27], v[88:91], v[52:55], v[24:27]
    v_mfma_f32_16x16x32_bf16 v[32:35], v[192:195], v[52:55], v[32:35]
    ds_read_b64 v[52:53], v4 offset:8960
    ds_read_b64 v[54:55], v5 offset:8960
    s_waitcnt lgkmcnt(10)
    v_mfma_f32_16x16x32_bf16 v[16:19], v[128:131], v[56:59], v[16:19]
    v_mfma_f32_16x16x32_bf16 v[16:19], v[88:91], v[56:59], v[16:19]
    v_mfma_f32_16x16x32_bf16 v[24:27], v[192:195], v[56:59], v[24:27]
    v_mfma_f32_16x16x32_bf16 v[32:35], v[224:227], v[56:59], v[32:35]
    ds_read_b128 v[56:59], v8 offset:3648
    s_waitcnt lgkmcnt(10)
    v_mfma_f32_16x16x32_bf16 v[36:39], v[160:163], v[60:63], v[36:39]
    v_mfma_f32_16x16x32_bf16 v[36:39], v[92:95], v[60:63], v[36:39]
    ds_read_b64 v[60:61], v4 offset:11008
    ds_read_b64 v[62:63], v5 offset:11008
    s_waitcnt lgkmcnt(11)
    v_mfma_f32_16x16x32_bf16 v[28:31], v[160:163], v[64:67], v[28:31]
    v_mfma_f32_16x16x32_bf16 v[28:31], v[92:95], v[64:67], v[28:31]
    v_mfma_f32_16x16x32_bf16 v[36:39], v[40:43], v[64:67], v[36:39]
    ds_read_b128 v[64:67], v8 offset:4704
    s_waitcnt lgkmcnt(11)
    v_mfma_f32_16x16x32_bf16 v[20:23], v[160:163], v[68:71], v[20:23]
    v_mfma_f32_16x16x32_bf16 v[20:23], v[92:95], v[68:71], v[20:23]
    v_mfma_f32_16x16x32_bf16 v[28:31], v[40:43], v[68:71], v[28:31]
    ds_read_b128 v[40:43], v8 offset:5216
    v_mfma_f32_16x16x32_bf16 v[36:39], v[44:47], v[68:71], v[36:39]
    ds_read_b128 v[68:71], v8 offset:5728
    ds_read_b128 v[44:47], v8 offset:2688
    s_waitcnt lgkmcnt(13)
    v_mfma_f32_16x16x32_bf16 v[32:35], v[132:135], v[72:75], v[32:35]
    ds_read_b128 v[72:75], v8 offset:3200
    s_waitcnt lgkmcnt(13)
    v_mfma_f32_16x16x32_bf16 v[24:27], v[132:135], v[76:79], v[24:27]
    v_mfma_f32_16x16x32_bf16 v[32:35], v[196:199], v[76:79], v[32:35]
    ds_read_b64 v[76:77], v6 offset:9216
    ds_read_b64 v[78:79], v7 offset:9216
    s_waitcnt lgkmcnt(14)
    v_mfma_f32_16x16x32_bf16 v[16:19], v[132:135], v[80:83], v[16:19]
    v_mfma_f32_16x16x32_bf16 v[24:27], v[196:199], v[80:83], v[24:27]
    v_mfma_f32_16x16x32_bf16 v[32:35], v[228:231], v[80:83], v[32:35]
    ds_read_b128 v[80:83], v8 offset:3712
    s_waitcnt lgkmcnt(14)
    v_mfma_f32_16x16x32_bf16 v[36:39], v[164:167], v[84:87], v[36:39]
    ds_read_b64 v[84:85], v6 offset:11264
    ds_read_b64 v[86:87], v7 offset:11264
    s_waitcnt lgkmcnt(15)
    v_mfma_f32_16x16x32_bf16 v[28:31], v[164:167], v[48:51], v[28:31]
    s_waitcnt lgkmcnt(13)
    v_mfma_f32_16x16x32_bf16 v[36:39], v[52:55], v[48:51], v[36:39]
    ds_read_b128 v[48:51], v8 offset:4768
    s_waitcnt lgkmcnt(13)
    v_mfma_f32_16x16x32_bf16 v[20:23], v[164:167], v[56:59], v[20:23]
    v_mfma_f32_16x16x32_bf16 v[28:31], v[52:55], v[56:59], v[28:31]
    ds_read_b128 v[52:55], v8 offset:5280
    s_waitcnt lgkmcnt(12)
    v_mfma_f32_16x16x32_bf16 v[36:39], v[60:63], v[56:59], v[36:39]
    ds_read_b128 v[56:59], v8 offset:5792
    ds_read_b128 v[60:63], v8 offset:2752
    s_waitcnt lgkmcnt(13)
    v_mfma_f32_16x16x32_bf16 v[32:35], v[136:139], v[64:67], v[32:35]
    ds_read_b128 v[64:67], v8 offset:3264
    s_waitcnt lgkmcnt(13)
    v_mfma_f32_16x16x32_bf16 v[24:27], v[136:139], v[40:43], v[24:27]
    v_mfma_f32_16x16x32_bf16 v[32:35], v[200:203], v[40:43], v[32:35]
    ds_read_b64 v[40:41], v4 offset:9472
    ds_read_b64 v[42:43], v5 offset:9472
    s_waitcnt lgkmcnt(14)
    v_mfma_f32_16x16x32_bf16 v[16:19], v[136:139], v[68:71], v[16:19]
    v_mfma_f32_16x16x32_bf16 v[24:27], v[200:203], v[68:71], v[24:27]
    v_mfma_f32_16x16x32_bf16 v[32:35], v[232:235], v[68:71], v[32:35]
    ds_read_b128 v[68:71], v8 offset:3776
    s_waitcnt lgkmcnt(14)
    v_mfma_f32_16x16x32_bf16 v[36:39], v[168:171], v[44:47], v[36:39]
    ds_read_b64 v[44:45], v4 offset:11520
    ds_read_b64 v[46:47], v5 offset:11520
    s_waitcnt lgkmcnt(15)
    v_mfma_f32_16x16x32_bf16 v[28:31], v[168:171], v[72:75], v[28:31]
    s_waitcnt lgkmcnt(13)
    v_mfma_f32_16x16x32_bf16 v[36:39], v[76:79], v[72:75], v[36:39]
    ds_read_b128 v[72:75], v8 offset:4832
    s_waitcnt lgkmcnt(13)
    v_mfma_f32_16x16x32_bf16 v[20:23], v[168:171], v[80:83], v[20:23]
    v_mfma_f32_16x16x32_bf16 v[28:31], v[76:79], v[80:83], v[28:31]
    ds_read_b128 v[76:79], v8 offset:5344
    s_waitcnt lgkmcnt(12)
    v_mfma_f32_16x16x32_bf16 v[36:39], v[84:87], v[80:83], v[36:39]
    ds_read_b128 v[80:83], v8 offset:5856
    ds_read_b128 v[84:87], v8 offset:2816
    s_waitcnt lgkmcnt(13)
    v_mfma_f32_16x16x32_bf16 v[32:35], v[140:143], v[48:51], v[32:35]
    ds_read_b128 v[48:51], v8 offset:3328
    s_waitcnt lgkmcnt(13)
    v_mfma_f32_16x16x32_bf16 v[24:27], v[140:143], v[52:55], v[24:27]
    v_mfma_f32_16x16x32_bf16 v[32:35], v[204:207], v[52:55], v[32:35]
    ds_read_b64 v[52:53], v6 offset:9728
    ds_read_b64 v[54:55], v7 offset:9728
    s_waitcnt lgkmcnt(14)
    v_mfma_f32_16x16x32_bf16 v[16:19], v[140:143], v[56:59], v[16:19]
    v_mfma_f32_16x16x32_bf16 v[24:27], v[204:207], v[56:59], v[24:27]
    v_mfma_f32_16x16x32_bf16 v[32:35], v[236:239], v[56:59], v[32:35]
    ds_read_b128 v[56:59], v8 offset:3840
    s_waitcnt lgkmcnt(14)
    v_mfma_f32_16x16x32_bf16 v[36:39], v[172:175], v[60:63], v[36:39]
    ds_read_b64 v[60:61], v6 offset:11776
    ds_read_b64 v[62:63], v7 offset:11776
    s_waitcnt lgkmcnt(15)
    v_mfma_f32_16x16x32_bf16 v[28:31], v[172:175], v[64:67], v[28:31]
    s_waitcnt lgkmcnt(13)
    v_mfma_f32_16x16x32_bf16 v[36:39], v[40:43], v[64:67], v[36:39]
    ds_read_b128 v[64:67], v8 offset:4896
    s_waitcnt lgkmcnt(13)
    v_mfma_f32_16x16x32_bf16 v[20:23], v[172:175], v[68:71], v[20:23]
    v_mfma_f32_16x16x32_bf16 v[28:31], v[40:43], v[68:71], v[28:31]
    ds_read_b128 v[40:43], v8 offset:5408
    s_waitcnt lgkmcnt(12)
    v_mfma_f32_16x16x32_bf16 v[36:39], v[44:47], v[68:71], v[36:39]
    ds_read_b128 v[68:71], v8 offset:5920
    ds_read_b128 v[44:47], v8 offset:2880
    s_setprio 2
    s_waitcnt lgkmcnt(13)
    v_mfma_f32_16x16x32_bf16 v[32:35], v[144:147], v[72:75], v[32:35]
    ds_read_b128 v[72:75], v8 offset:3392
    s_waitcnt lgkmcnt(13)
    v_mfma_f32_16x16x32_bf16 v[24:27], v[144:147], v[76:79], v[24:27]
    v_mfma_f32_16x16x32_bf16 v[32:35], v[208:211], v[76:79], v[32:35]
    ds_read_b64 v[76:77], v4 offset:9984
    ds_read_b64 v[78:79], v5 offset:9984
    s_waitcnt lgkmcnt(14)
    v_mfma_f32_16x16x32_bf16 v[16:19], v[144:147], v[80:83], v[16:19]
    v_mfma_f32_16x16x32_bf16 v[24:27], v[208:211], v[80:83], v[24:27]
    v_mfma_f32_16x16x32_bf16 v[32:35], v[240:243], v[80:83], v[32:35]
    ds_read_b128 v[80:83], v8 offset:3904
    s_waitcnt lgkmcnt(14)
    v_mfma_f32_16x16x32_bf16 v[36:39], v[176:179], v[84:87], v[36:39]
    ds_read_b64 v[84:85], v4 offset:12032
    ds_read_b64 v[86:87], v5 offset:12032
    s_waitcnt lgkmcnt(15)
    v_mfma_f32_16x16x32_bf16 v[28:31], v[176:179], v[48:51], v[28:31]
    s_waitcnt lgkmcnt(13)
    v_mfma_f32_16x16x32_bf16 v[36:39], v[52:55], v[48:51], v[36:39]
    ds_read_b128 v[48:51], v8 offset:4960
    s_waitcnt lgkmcnt(13)
    v_mfma_f32_16x16x32_bf16 v[20:23], v[176:179], v[56:59], v[20:23]
    global_load_dwordx4 v[100:103], v14, s[8:9]
    v_add_u32 v14, 294912, v14
    global_load_dwordx4 v[104:107], v14, s[8:9]
    v_add_u32 v14, 294912, v14
    global_load_dwordx4 v[108:111], v14, s[8:9]
    v_mfma_f32_16x16x32_bf16 v[28:31], v[52:55], v[56:59], v[28:31]
    ds_read_b128 v[52:55], v8 offset:5472
    s_waitcnt lgkmcnt(12)
    v_mfma_f32_16x16x32_bf16 v[36:39], v[60:63], v[56:59], v[36:39]
    ds_read_b128 v[56:59], v8 offset:5984
    ds_read_b128 v[60:63], v8 offset:2944
    s_waitcnt lgkmcnt(13)
    v_mfma_f32_16x16x32_bf16 v[32:35], v[148:151], v[64:67], v[32:35]
    ds_read_b128 v[64:67], v8 offset:3456
    s_waitcnt lgkmcnt(13)
    v_mfma_f32_16x16x32_bf16 v[24:27], v[148:151], v[40:43], v[24:27]
    v_mfma_f32_16x16x32_bf16 v[32:35], v[212:215], v[40:43], v[32:35]
    ds_read_b64 v[40:41], v6 offset:10240
    ds_read_b64 v[42:43], v7 offset:10240
    s_waitcnt lgkmcnt(14)
    v_mfma_f32_16x16x32_bf16 v[16:19], v[148:151], v[68:71], v[16:19]
    v_mfma_f32_16x16x32_bf16 v[24:27], v[212:215], v[68:71], v[24:27]
    v_mfma_f32_16x16x32_bf16 v[32:35], v[244:247], v[68:71], v[32:35]
    ds_read_b128 v[68:71], v8 offset:3968
    s_waitcnt lgkmcnt(14)
    v_mfma_f32_16x16x32_bf16 v[36:39], v[180:183], v[44:47], v[36:39]
    ds_read_b64 v[44:45], v6 offset:12288
    ds_read_b64 v[46:47], v7 offset:12288
    s_waitcnt lgkmcnt(15)
    v_mfma_f32_16x16x32_bf16 v[28:31], v[180:183], v[72:75], v[28:31]
    s_waitcnt lgkmcnt(13)
    v_mfma_f32_16x16x32_bf16 v[36:39], v[76:79], v[72:75], v[36:39]
    ds_read_b128 v[72:75], v8 offset:5024
    s_waitcnt lgkmcnt(13)
    v_mfma_f32_16x16x32_bf16 v[20:23], v[180:183], v[80:83], v[20:23]
    v_mfma_f32_16x16x32_bf16 v[28:31], v[76:79], v[80:83], v[28:31]
    ds_read_b128 v[76:79], v8 offset:5536
    s_waitcnt lgkmcnt(12)
    v_mfma_f32_16x16x32_bf16 v[36:39], v[84:87], v[80:83], v[36:39]
    ds_read_b128 v[80:83], v8 offset:6048
    ds_read_b128 v[84:87], v8 offset:3008
    s_setprio 1
    s_waitcnt lgkmcnt(13)
    v_mfma_f32_16x16x32_bf16 v[32:35], v[152:155], v[48:51], v[32:35]
    ds_read_b128 v[48:51], v8 offset:3520
    s_waitcnt lgkmcnt(13)
    v_mfma_f32_16x16x32_bf16 v[24:27], v[152:155], v[52:55], v[24:27]
    v_mfma_f32_16x16x32_bf16 v[32:35], v[216:219], v[52:55], v[32:35]
    ds_read_b64 v[52:53], v4 offset:10496
    ds_read_b64 v[54:55], v5 offset:10496
    s_waitcnt lgkmcnt(14)
    v_mfma_f32_16x16x32_bf16 v[16:19], v[152:155], v[56:59], v[16:19]
    v_mfma_f32_16x16x32_bf16 v[24:27], v[216:219], v[56:59], v[24:27]
    v_mfma_f32_16x16x32_bf16 v[32:35], v[248:251], v[56:59], v[32:35]
    ds_read_b128 v[56:59], v8 offset:4032
    s_waitcnt lgkmcnt(14)
    v_mfma_f32_16x16x32_bf16 v[36:39], v[184:187], v[60:63], v[36:39]
    ds_read_b64 v[60:61], v4 offset:12544
    ds_read_b64 v[62:63], v5 offset:12544
    s_waitcnt lgkmcnt(15)
    v_mfma_f32_16x16x32_bf16 v[28:31], v[184:187], v[64:67], v[28:31]
    s_waitcnt lgkmcnt(13)
    v_mfma_f32_16x16x32_bf16 v[36:39], v[40:43], v[64:67], v[36:39]
    s_waitcnt lgkmcnt(12)
    v_mfma_f32_16x16x32_bf16 v[20:23], v[184:187], v[68:71], v[20:23]
    v_mfma_f32_16x16x32_bf16 v[28:31], v[40:43], v[68:71], v[28:31]
    s_waitcnt lgkmcnt(10)
    v_mfma_f32_16x16x32_bf16 v[36:39], v[44:47], v[68:71], v[36:39]
    s_setprio 0
    s_waitcnt lgkmcnt(9)
    v_mfma_f32_16x16x32_bf16 v[32:35], v[156:159], v[72:75], v[32:35]
    s_waitcnt lgkmcnt(8)
    v_mfma_f32_16x16x32_bf16 v[24:27], v[156:159], v[76:79], v[24:27]
    v_mfma_f32_16x16x32_bf16 v[32:35], v[220:223], v[76:79], v[32:35]
    s_waitcnt lgkmcnt(7)
    v_mfma_f32_16x16x32_bf16 v[16:19], v[156:159], v[80:83], v[16:19]
    v_mfma_f32_16x16x32_bf16 v[24:27], v[220:223], v[80:83], v[24:27]
    v_mfma_f32_16x16x32_bf16 v[32:35], v[252:255], v[80:83], v[32:35]
    s_waitcnt lgkmcnt(6)
    v_mfma_f32_16x16x32_bf16 v[36:39], v[188:191], v[84:87], v[36:39]
    s_waitcnt lgkmcnt(5)
    v_mfma_f32_16x16x32_bf16 v[28:31], v[188:191], v[48:51], v[28:31]
    s_waitcnt lgkmcnt(3)
    v_mfma_f32_16x16x32_bf16 v[36:39], v[52:55], v[48:51], v[36:39]
    s_waitcnt lgkmcnt(2)
    v_mfma_f32_16x16x32_bf16 v[20:23], v[188:191], v[56:59], v[20:23]
    v_mfma_f32_16x16x32_bf16 v[28:31], v[52:55], v[56:59], v[28:31]
    s_waitcnt lgkmcnt(0)
    v_mfma_f32_16x16x32_bf16 v[36:39], v[60:63], v[56:59], v[36:39]
    s_nop 4
    v_cvt_pk_bf16_f32 v40, v16, v20
    v_cvt_pk_bf16_f32 v41, v17, v21
    v_cvt_pk_bf16_f32 v42, v18, v22
    v_cvt_pk_bf16_f32 v43, v19, v23
    ds_write_b128 v9, v[40:43] offset:0
    v_cvt_pk_bf16_f32 v44, v24, v28
    v_cvt_pk_bf16_f32 v45, v25, v29
    v_cvt_pk_bf16_f32 v46, v26, v30
    v_cvt_pk_bf16_f32 v47, v27, v31
    ds_write_b128 v9, v[44:47] offset:1280
    v_cvt_pk_bf16_f32 v48, v32, v36
    v_cvt_pk_bf16_f32 v49, v33, v37
    v_cvt_pk_bf16_f32 v50, v34, v38
    v_cvt_pk_bf16_f32 v51, v35, v39
    ds_write_b128 v9, v[48:51] offset:2560
    s_waitcnt lgkmcnt(0)
    s_barrier
    ds_read_b64_tr_b16 v[52:53], v10 offset:0
    ds_read_b64_tr_b16 v[54:55], v11 offset:0
    ds_read_b64_tr_b16 v[56:57], v10 offset:1280
    ds_read_b64_tr_b16 v[58:59], v11 offset:1280
    ds_read_b64_tr_b16 v[60:61], v10 offset:2560
    ds_read_b64_tr_b16 v[62:63], v11 offset:2560
    s_waitcnt vmcnt(0)
    s_waitcnt lgkmcnt(4)
    v_lshlrev_b32 v64, 16, v52
    v_and_b32 v65, 0xffff0000, v52
    v_lshlrev_b32 v66, 16, v100
    v_and_b32 v67, 0xffff0000, v100
    v_pk_mul_f32 v[64:65], v[64:65], v[66:67]
    v_cvt_pk_bf16_f32 v68, v64, v65
    v_lshlrev_b32 v64, 16, v53
    v_and_b32 v65, 0xffff0000, v53
    v_lshlrev_b32 v66, 16, v101
    v_and_b32 v67, 0xffff0000, v101
    v_pk_mul_f32 v[64:65], v[64:65], v[66:67]
    v_cvt_pk_bf16_f32 v69, v64, v65
    v_lshlrev_b32 v64, 16, v54
    v_and_b32 v65, 0xffff0000, v54
    v_lshlrev_b32 v66, 16, v102
    v_and_b32 v67, 0xffff0000, v102
    v_pk_mul_f32 v[64:65], v[64:65], v[66:67]
    v_cvt_pk_bf16_f32 v70, v64, v65
    v_lshlrev_b32 v64, 16, v55
    v_and_b32 v65, 0xffff0000, v55
    v_lshlrev_b32 v66, 16, v103
    v_and_b32 v67, 0xffff0000, v103
    v_pk_mul_f32 v[64:65], v[64:65], v[66:67]
    v_cvt_pk_bf16_f32 v71, v64, v65
    global_store_dwordx4 v15, v[68:71], s[30:31]
    v_add_u32 v15, 589824, v15
    s_waitcnt lgkmcnt(2)
    v_lshlrev_b32 v64, 16, v56
    v_and_b32 v65, 0xffff0000, v56
    v_lshlrev_b32 v66, 16, v104
    v_and_b32 v67, 0xffff0000, v104
    v_pk_mul_f32 v[64:65], v[64:65], v[66:67]
    v_cvt_pk_bf16_f32 v72, v64, v65
    v_lshlrev_b32 v64, 16, v57
    v_and_b32 v65, 0xffff0000, v57
    v_lshlrev_b32 v66, 16, v105
    v_and_b32 v67, 0xffff0000, v105
    v_pk_mul_f32 v[64:65], v[64:65], v[66:67]
    v_cvt_pk_bf16_f32 v73, v64, v65
    v_lshlrev_b32 v64, 16, v58
    v_and_b32 v65, 0xffff0000, v58
    v_lshlrev_b32 v66, 16, v106
    v_and_b32 v67, 0xffff0000, v106
    v_pk_mul_f32 v[64:65], v[64:65], v[66:67]
    v_cvt_pk_bf16_f32 v74, v64, v65
    v_lshlrev_b32 v64, 16, v59
    v_and_b32 v65, 0xffff0000, v59
    v_lshlrev_b32 v66, 16, v107
    v_and_b32 v67, 0xffff0000, v107
    v_pk_mul_f32 v[64:65], v[64:65], v[66:67]
    v_cvt_pk_bf16_f32 v75, v64, v65
    global_store_dwordx4 v15, v[72:75], s[30:31]
    v_add_u32 v15, 589824, v15
    s_waitcnt lgkmcnt(0)
    v_lshlrev_b32 v64, 16, v60
    v_and_b32 v65, 0xffff0000, v60
    v_lshlrev_b32 v66, 16, v108
    v_and_b32 v67, 0xffff0000, v108
    v_pk_mul_f32 v[64:65], v[64:65], v[66:67]
    v_cvt_pk_bf16_f32 v76, v64, v65
    v_lshlrev_b32 v64, 16, v61
    v_and_b32 v65, 0xffff0000, v61
    v_lshlrev_b32 v66, 16, v109
    v_and_b32 v67, 0xffff0000, v109
    v_pk_mul_f32 v[64:65], v[64:65], v[66:67]
    v_cvt_pk_bf16_f32 v77, v64, v65
    v_lshlrev_b32 v64, 16, v62
    v_and_b32 v65, 0xffff0000, v62
    v_lshlrev_b32 v66, 16, v110
    v_and_b32 v67, 0xffff0000, v110
    v_pk_mul_f32 v[64:65], v[64:65], v[66:67]
    v_cvt_pk_bf16_f32 v78, v64, v65
    v_lshlrev_b32 v64, 16, v63
    v_and_b32 v65, 0xffff0000, v63
    v_lshlrev_b32 v66, 16, v111
    v_and_b32 v67, 0xffff0000, v111
    v_pk_mul_f32 v[64:65], v[64:65], v[66:67]
    v_cvt_pk_bf16_f32 v79, v64, v65
    global_store_dwordx4 v15, v[76:79], s[30:31]
    s_branch L_fin
L_misc:
    s_waitcnt lgkmcnt(0)
    s_cmp_eq_u32 s48, 7
    s_cbranch_scc0 L_b2
    s_cmp_eq_u32 s3, 0
    s_cbranch_scc0 L_end
    s_add_u32 s26, s34, 5308416
    s_addc_u32 s27, s35, 0
    s_load_dwordx2 s[28:29], s[26:27], 0
    s_waitcnt lgkmcnt(0)
    s_mul_i32 s28, s28, 0x9e3779b1
    s_add_u32 s28, s28, 0x7f4a7c15
    s_mul_i32 s29, s29, 0x85ebca6d
    s_add_u32 s29, s29, 0x165667b1
    v_and_b32 v2, 255, v0
    v_and_b32 v3, 0xe7, v2
    v_cmp_eq_u32 vcc, 7, v3
    s_nop 1
    v_cndmask_b32_e64 v2, v2, 32, vcc
    v_lshlrev_b32 v2, 7, v2
    v_add_u32 v2, 5275648, v2
    s_mov_b32 s49, 0
L_bump:
    global_load_dwordx2 v[4:5], v2, s[34:35] sc1
    s_add_u32 s49, s49, 1
    s_cmp_gt_u32 s49, 0x40000
    s_waitcnt vmcnt(0)
    v_cmp_ne_u64 vcc, s[28:29], v[4:5]
    s_cbranch_scc1 L_bumpx
    s_cbranch_vccz L_bumpx
    s_sleep 8
    s_branch L_bump
L_bumpx:
    s_cmp_lg_u32 s6, 0
    s_barrier
    s_cbranch_scc1 L_fin
    v_mov_b32 v2, 5308416
    v_mov_b32 v4, s28
    v_mov_b32 v5, s29
    s_mov_b64 exec, 1
    global_store_dwordx2 v2, v[4:5], s[34:35] sc1
    s_mov_b64 exec, -1
    s_branch L_fin
L_b1:
    v_lshrrev_b32 v4, 4, v0
    v_and_b32 v5, 15, v0
    v_lshlrev_b32 v6, 6, v4
    v_add_u32 v6, s7, v6
    v_mul_u32_u24 v6, 1152, v6
    v_lshl_add_u32 v6, v5, 3, v6
    s_waitcnt lgkmcnt(0)
    global_load_dwordx2 v[32:33], v6, s[20:21] offset:0 nt
    global_load_dwordx2 v[34:35], v6, s[20:21] offset:128 nt
    global_load_dwordx2 v[36:37], v6, s[20:21] offset:256 nt
    global_load_dwordx2 v[38:39], v6, s[20:21] offset:384 nt
    global_load_dwordx2 v[40:41], v6, s[20:21] offset:512 nt
    global_load_dwordx2 v[42:43], v6, s[20:21] offset:640 nt
    global_load_dwordx2 v[44:45], v6, s[20:21] offset:768 nt
    global_load_dwordx2 v[46:47], v6, s[20:21] offset:896 nt
    global_load_dwordx2 v[48:49], v6, s[20:21] offset:1024 nt
    s_add_u32 s26, s34, 5308416
    s_addc_u32 s27, s35, 0
    s_load_dwordx2 s[28:29], s[26:27], 0
    v_lshrrev_b32 v7, 1, v5
    v_and_b32 v8, 15, v4
    v_xor_b32 v8, v8, v7
    v_lshlrev_b32 v8, 4, v8
    v_lshl_add_u32 v8, v7, 8, v8
    v_and_b32 v7, 1, v5
    v_lshl_add_u32 v8, v7, 3, v8
    v_lshrrev_b32 v7, 4, v4
    v_lshl_add_u32 v8, v7, 11, v8
    v_lshlrev_b32 v7, 2, v5
    v_mul_u32_u24 v9, 57, v7
    v_lshrrev_b32 v9, 9, v9
    v_mul_u32_u24 v9, 9, v9
    v_sub_u32 v7, v7, v9
    v_lshl_add_u32 v200, v7, 12, v8
    v_add_u32 v9, 4096, v200
    v_add_u32 v10, 4294934528, v200
    v_min_u32 v201, v9, v10
    v_add_u32 v9, 8192, v200
    v_add_u32 v10, 4294938624, v200
    v_min_u32 v202, v9, v10
    v_add_u32 v9, 12288, v200
    v_add_u32 v10, 4294942720, v200
    v_min_u32 v203, v9, v10
    v_add_u32 v9, 16384, v200
    v_add_u32 v10, 4294946816, v200
    v_min_u32 v204, v9, v10
    v_add_u32 v9, 20480, v200
    v_add_u32 v10, 4294950912, v200
    v_min_u32 v205, v9, v10
    v_add_u32 v9, 24576, v200
    v_add_u32 v10, 4294955008, v200
    v_min_u32 v206, v9, v10
    v_add_u32 v9, 28672, v200
    v_add_u32 v10, 4294959104, v200
    v_min_u32 v207, v9, v10
    v_add_u32 v9, 32768, v200
    v_add_u32 v10, 4294963200, v200
    v_min_u32 v208, v9, v10
    v_and_b32 v2, 15, v1
    v_lshrrev_b32 v3, 4, v1
    s_lshr_b32 s50, s6, 1
    s_and_b32 s51, s6, 1
    s_and_b32 s52, s6, 2
    s_lshr_b32 s53, s6, 2
    s_add_u32 s52, s52, s53
    v_lshl_add_u32 v22, s50, 4, v2
    v_lshrrev_b32 v20, 1, v22
    v_and_b32 v21, 1, v2
    v_cvt_f32_u32 v21, v21
    v_mul_f32 v21, 0xbe800000, v21
    v_cmp_eq_u32 vcc, 1, v22
    v_mul_u32_u24 v20, 57, v20
    v_and_b32 v20, 63, v20
    v_cndmask_b32_e64 v20, v20, 32, vcc
    v_cndmask_b32_e64 v21, v21, 0, vcc
    v_cvt_f32_u32 v20, v20
    v_mul_f32 v20, 0x3c800000, v20
    v_lshlrev_b32 v22, 3, v3
    v_cvt_f32_u32 v22, v22
    v_fma_f32 v21, v20, v22, v21
    v_mul_f32 v23, 0x41c00000, v20
    v_cos_f32 v24, v21
    v_add_f32 v21, v21, v20
    v_cos_f32 v25, v21
    v_add_f32 v21, v21, v20
    v_cvt_pk_bf16_f32 v68, v24, v25
    v_cos_f32 v24, v21
    v_add_f32 v21, v21, v20
    v_cos_f32 v25, v21
    v_add_f32 v21, v21, v20
    v_cvt_pk_bf16_f32 v69, v24, v25
    v_cos_f32 v24, v21
    v_add_f32 v21, v21, v20
    v_cos_f32 v25, v21
    v_add_f32 v21, v21, v20
    v_cvt_pk_bf16_f32 v70, v24, v25
    v_cos_f32 v24, v21
    v_add_f32 v21, v21, v20
    v_cos_f32 v25, v21
    v_add_f32 v21, v21, v20
    v_cvt_pk_bf16_f32 v71, v24, v25
    v_add_f32 v21, v21, v23
    v_cos_f32 v24, v21
    v_add_f32 v21, v21, v20
    v_cos_f32 v25, v21
    v_add_f32 v21, v21, v20
    v_cvt_pk_bf16_f32 v72, v24, v25
    v_cos_f32 v24, v21
    v_add_f32 v21, v21, v20
    v_cos_f32 v25, v21
    v_add_f32 v21, v21, v20
    v_cvt_pk_bf16_f32 v73, v24, v25
    v_cos_f32 v24, v21
    v_add_f32 v21, v21, v20
    v_cos_f32 v25, v21
    v_add_f32 v21, v21, v20
    v_cvt_pk_bf16_f32 v74, v24, v25
    v_cos_f32 v24, v21
    v_add_f32 v21, v21, v20
    v_cos_f32 v25, v21
    v_add_f32 v21, v21, v20
    v_cvt_pk_bf16_f32 v75, v24, v25
    v_lshl_add_u32 v22, s51, 4, v2
    v_lshrrev_b32 v20, 1, v22
    v_and_b32 v21, 1, v2
    v_cvt_f32_u32 v21, v21
    v_mul_f32 v21, 0xbe800000, v21
    v_cmp_eq_u32 vcc, 1, v22
    s_nop 1
    v_cndmask_b32_e64 v20, v20, 16, vcc
    v_cndmask_b32_e64 v21, v21, 0, vcc
    v_cvt_f32_u32 v20, v20
    v_mul_f32 v20, 0x3d000000, v20
    v_lshlrev_b32 v22, 2, v3
    v_cvt_f32_u32 v22, v22
    v_fma_f32 v21, v20, v22, v21
    v_mul_f32 v23, 0x41400000, v20
    v_cos_f32 v24, v21
    v_add_f32 v21, v21, v20
    v_cos_f32 v25, v21
    v_add_f32 v21, v21, v20
    v_cvt_pk_bf16_f32 v76, v24, v25
    v_cos_f32 v24, v21
    v_add_f32 v21, v21, v20
    v_cos_f32 v25, v21
    v_add_f32 v21, v21, v20
    v_cvt_pk_bf16_f32 v77, v24, v25
    v_add_f32 v21, v21, v23
    v_cos_f32 v24, v21
    v_add_f32 v21, v21, v20
    v_cos_f32 v25, v21
    v_add_f32 v21, v21, v20
    v_cvt_pk_bf16_f32 v78, v24, v25
    v_cos_f32 v24, v21
    v_add_f32 v21, v21, v20
    v_cos_f32 v25, v21
    v_add_f32 v21, v21, v20
    v_cvt_pk_bf16_f32 v79, v24, v25
    s_lshl_b32 s49, s51, 11
    v_xor_b32 v10, v2, v3
    v_lshlrev_b32 v10, 4, v10
    v_lshl_add_u32 v10, v3, 8, v10
    v_add_u32 v10, s49, v10
    v_xor_b32 v11, 64, v10
    v_add_u32 v11, 1024, v11
    v_lshl_add_u32 v12, s51, 4, v2
    v_mul_u32_u24 v12, 1288, v12
    v_add_u32 v12, 36864, v12
    s_lshl_b32 s49, s50, 3
    v_lshrrev_b32 v13, 1, v3
    v_mul_u32_u24 v13, 320, v13
    v_and_b32 v14, 1, v3
    v_lshl_add_u32 v13, v14, 2, v13
    v_add3_u32 v13, v13, v12, s49
    s_sub_u32 s49, 36, s49
    v_lshlrev_b32 v14, 1, v3
    v_sub_u32 v14, s49, v14
    v_mul_u32_u24 v9, 57, v14
    v_lshrrev_b32 v9, 9, v9
    v_mul_u32_u24 v9, 9, v9
    v_sub_u32 v14, v14, v9
    v_lshlrev_b32 v14, 5, v14
    v_add_u32 v116, v14, v13
    v_add_u32 v9, 32, v14
    v_add_u32 v15, 4294967040, v14
    v_min_u32 v9, v9, v15
    v_add_u32 v117, v9, v13
    v_add_u32 v9, 64, v14
    v_add_u32 v15, 4294967072, v14
    v_min_u32 v9, v9, v15
    v_add_u32 v118, v9, v13
    v_add_u32 v9, 96, v14
    v_add_u32 v15, 4294967104, v14
    v_min_u32 v9, v9, v15
    v_add_u32 v119, v9, v13
    v_add_u32 v9, 128, v14
    v_add_u32 v15, 4294967136, v14
    v_min_u32 v9, v9, v15
    v_add_u32 v120, v9, v13
    v_add_u32 v9, 160, v14
    v_add_u32 v15, 4294967168, v14
    v_min_u32 v9, v9, v15
    v_add_u32 v121, v9, v13
    v_add_u32 v9, 192, v14
    v_add_u32 v15, 4294967200, v14
    v_min_u32 v9, v9, v15
    v_add_u32 v122, v9, v13
    v_add_u32 v9, 224, v14
    v_add_u32 v15, 4294967232, v14
    v_min_u32 v9, v9, v15
    v_add_u32 v123, v9, v13
    v_add_u32 v9, 256, v14
    v_add_u32 v15, 4294967264, v14
    v_min_u32 v9, v9, v15
    v_add_u32 v124, v9, v13
    v_lshrrev_b32 v14, 2, v1
    v_mul_u32_u24 v14, 1288, v14
    v_and_b32 v9, 3, v1
    v_mul_u32_u24 v15, 320, v9
    s_lshl_b32 s49, s52, 4
    s_add_u32 s49, s49, 36864
    v_add3_u32 v14, v14, v15, s49
    v_lshrrev_b32 v15, 2, v2
    v_lshl_add_u32 v15, s51, 2, v15
    v_mul_u32_u24 v15, 311296, v15
    v_lshl_add_u32 v15, v3, 6, v15
    v_lshl_add_u32 v15, v9, 4, v15
    s_lshl_b32 s49, s52, 14
    s_lshl_b32 s54, s7, 8
    s_add_u32 s49, s49, s54
    s_add_u32 s49, s49, 2359296
    v_add_u32 v15, s49, v15
    s_mov_b32 s60, 0x3f441b7d
    s_mov_b32 s61, s60
    s_mov_b32 s62, 0x3e31d0d4
    s_mov_b32 s63, s62
    s_mov_b32 s64, 0xbf708fb2
    s_mov_b32 s65, s64
    s_mov_b32 s66, 0x3f248dbb
    s_mov_b32 s67, s66
    s_mov_b32 s68, 0x3f7c1c5c
    s_mov_b32 s69, s68
    s_mov_b32 s70, 0x3f5db3d7
    s_mov_b32 s71, s70
    s_mov_b32 s72, 0x3eaf1d44
    s_mov_b32 s73, s72
    s_mov_b32 s74, 0xbf000000
    s_mov_b32 s75, s74
    s_lshl_b32 s49, s48, 3
    s_add_u32 s49, s49, s6
    s_lshl_b32 s49, s49, 7
    s_add_u32 s49, s49, 5312512
    v_lshl_add_u32 v29, v1, 3, s49
    v_mov_b32 v30, 0
    v_mov_b32 v31, 0
    v_mov_b32 v9, 0xffff
    s_waitcnt vmcnt(0)
    v_bfi_b32 v50, v9, v32, v48
    v_bfi_b32 v51, v9, v47, v45
    ds_write_b64 v200, v[50:51]
    v_bfi_b32 v52, v9, v34, v32
    v_bfi_b32 v53, v9, v49, v47
    ds_write_b64 v201, v[52:53]
    v_bfi_b32 v54, v9, v36, v34
    v_bfi_b32 v55, v9, v33, v49
    ds_write_b64 v202, v[54:55]
    v_bfi_b32 v56, v9, v38, v36
    v_bfi_b32 v57, v9, v35, v33
    ds_write_b64 v203, v[56:57]
    v_bfi_b32 v58, v9, v40, v38
    v_bfi_b32 v59, v9, v37, v35
    ds_write_b64 v204, v[58:59]
    v_bfi_b32 v60, v9, v42, v40
    v_bfi_b32 v61, v9, v39, v37
    ds_write_b64 v205, v[60:61]
    v_bfi_b32 v62, v9, v44, v42
    v_bfi_b32 v63, v9, v41, v39
    ds_write_b64 v206, v[62:63]
    v_bfi_b32 v64, v9, v46, v44
    v_bfi_b32 v65, v9, v43, v41
    ds_write_b64 v207, v[64:65]
    v_bfi_b32 v66, v9, v48, v46
    v_bfi_b32 v67, v9, v45, v43
    ds_write_b64 v208, v[66:67]
    s_waitcnt lgkmcnt(0)
    s_barrier
    s_mul_i32 s28, s28, 0x9e3779b1
    s_add_u32 s28, s28, 0x7f4a7c15
    s_mul_i32 s29, s29, 0x85ebca6d
    s_add_u32 s29, s29, 0x165667b1
    s_mov_b64 exec, 1
    global_atomic_add_x2 v29, v[30:31], s[34:35] sc1
    s_mov_b64 exec, -1
    s_setprio 1
    ds_read_b128 v[128:131], v10 offset:4096
    ds_read_b128 v[132:135], v11 offset:4096
    ds_read_b128 v[136:139], v10 offset:32768
    ds_read_b128 v[140:143], v11 offset:32768
    ds_read_b128 v[144:147], v10 offset:8192
    ds_read_b128 v[148:151], v11 offset:8192
    ds_read_b128 v[152:155], v10 offset:28672
    ds_read_b128 v[156:159], v11 offset:28672
    ds_read_b128 v[160:163], v10 offset:16384
    ds_read_b128 v[164:167], v11 offset:16384
    ds_read_b128 v[168:171], v10 offset:20480
    ds_read_b128 v[172:175], v11 offset:20480
    ds_read_b128 v[176:179], v10 offset:12288
    ds_read_b128 v[180:183], v11 offset:12288
    ds_read_b128 v[184:187], v10 offset:24576
    ds_read_b128 v[188:191], v11 offset:24576
    ds_read_b128 v[192:195], v10 offset:0
    ds_read_b128 v[196:199], v11 offset:0
    s_waitcnt lgkmcnt(15)
    v_mfma_f32_16x16x32_bf16 v[84:87], v[68:71], v[128:131], 0
    s_waitcnt lgkmcnt(15)
    v_mfma_f32_16x16x32_bf16 v[84:87], v[72:75], v[132:135], v[84:87]
    s_waitcnt lgkmcnt(15)
    v_mfma_f32_16x16x32_bf16 v[112:115], v[68:71], v[136:139], 0
    s_waitcnt lgkmcnt(14)
    v_mfma_f32_16x16x32_bf16 v[112:115], v[72:75], v[140:143], v[112:115]
    s_waitcnt lgkmcnt(13)
    v_mfma_f32_16x16x32_bf16 v[88:91], v[68:71], v[144:147], 0
    s_waitcnt lgkmcnt(12)
    v_mfma_f32_16x16x32_bf16 v[88:91], v[72:75], v[148:151], v[88:91]
    s_waitcnt lgkmcnt(11)
    v_mfma_f32_16x16x32_bf16 v[108:111], v[68:71], v[152:155], 0
    s_waitcnt lgkmcnt(10)
    v_mfma_f32_16x16x32_bf16 v[108:111], v[72:75], v[156:159], v[108:111]
    s_waitcnt lgkmcnt(9)
    v_mfma_f32_16x16x32_bf16 v[96:99], v[68:71], v[160:163], 0
    s_waitcnt lgkmcnt(8)
    v_mfma_f32_16x16x32_bf16 v[96:99], v[72:75], v[164:167], v[96:99]
    s_waitcnt lgkmcnt(7)
    v_mfma_f32_16x16x32_bf16 v[100:103], v[68:71], v[168:171], 0
    s_waitcnt lgkmcnt(6)
    v_mfma_f32_16x16x32_bf16 v[100:103], v[72:75], v[172:175], v[100:103]
    s_waitcnt lgkmcnt(5)
    v_mfma_f32_16x16x32_bf16 v[92:95], v[68:71], v[176:179], 0
    s_waitcnt lgkmcnt(4)
    v_mfma_f32_16x16x32_bf16 v[92:95], v[72:75], v[180:183], v[92:95]
    s_waitcnt lgkmcnt(3)
    v_mfma_f32_16x16x32_bf16 v[104:107], v[68:71], v[184:187], 0
    s_waitcnt lgkmcnt(2)
    v_mfma_f32_16x16x32_bf16 v[104:107], v[72:75], v[188:191], v[104:107]
    s_waitcnt lgkmcnt(1)
    v_mfma_f32_16x16x32_bf16 v[80:83], v[68:71], v[192:195], 0
    s_waitcnt lgkmcnt(0)
    v_mfma_f32_16x16x32_bf16 v[80:83], v[72:75], v[196:199], v[80:83]
    v_pk_add_f32 v[128:129], v[84:85], v[112:113]
    v_pk_add_f32 v[136:137], v[84:85], v[112:113] neg_lo:[0,1] neg_hi:[0,1]
    v_pk_add_f32 v[172:173], v[86:87], v[114:115]
    v_pk_add_f32 v[180:181], v[86:87], v[114:115] neg_lo:[0,1] neg_hi:[0,1]
    v_pk_add_f32 v[130:131], v[88:89], v[108:109]
    v_pk_add_f32 v[138:139], v[88:89], v[108:109] neg_lo:[0,1] neg_hi:[0,1]
    v_pk_add_f32 v[174:175], v[90:91], v[110:111]
    v_pk_add_f32 v[182:183], v[90:91], v[110:111] neg_lo:[0,1] neg_hi:[0,1]
    v_pk_add_f32 v[134:135], v[96:97], v[100:101]
    v_pk_add_f32 v[142:143], v[96:97], v[100:101] neg_lo:[0,1] neg_hi:[0,1]
    v_pk_add_f32 v[178:179], v[98:99], v[102:103]
    v_pk_add_f32 v[186:187], v[98:99], v[102:103] neg_lo:[0,1] neg_hi:[0,1]
    v_pk_add_f32 v[132:133], v[92:93], v[104:105]
    v_pk_add_f32 v[140:141], v[92:93], v[104:105] neg_lo:[0,1] neg_hi:[0,1]
    v_pk_add_f32 v[176:177], v[94:95], v[106:107]
    v_pk_add_f32 v[184:185], v[94:95], v[106:107] neg_lo:[0,1] neg_hi:[0,1]
    v_pk_add_f32 v[144:145], v[128:129], v[130:131]
    v_pk_add_f32 v[150:151], v[128:129], v[134:135] neg_lo:[0,1] neg_hi:[0,1]
    v_pk_add_f32 v[152:153], v[130:131], v[134:135] neg_lo:[0,1] neg_hi:[0,1]
    v_pk_add_f32 v[144:145], v[144:145], v[134:135]
    v_pk_add_f32 v[146:147], v[80:81], v[132:133]
    v_pk_fma_f32 v[148:149], v[132:133], s[74:75], v[80:81]
    v_pk_add_f32 v[154:155], v[146:147], v[144:145]
    v_pk_fma_f32 v[160:161], v[144:145], s[74:75], v[146:147]
    v_pk_fma_f32 v[156:157], v[150:151], s[60:61], v[148:149]
    v_pk_fma_f32 v[158:159], v[150:151], s[62:63], v[148:149]
    v_pk_fma_f32 v[162:163], v[150:151], s[64:65], v[148:149]
    v_pk_fma_f32 v[156:157], v[152:153], s[62:63], v[156:157]
    v_pk_fma_f32 v[158:159], v[152:153], s[64:65], v[158:159]
    v_pk_fma_f32 v[162:163], v[152:153], s[60:61], v[162:163]
    v_pk_add_f32 v[168:169], v[136:137], v[138:139] neg_lo:[0,1] neg_hi:[0,1]
    v_pk_add_f32 v[150:151], v[136:137], v[138:139]
    v_pk_add_f32 v[152:153], v[138:139], v[142:143]
    v_pk_mul_f32 v[140:141], v[140:141], s[70:71]
    v_pk_add_f32 v[168:169], v[168:169], v[142:143]
    v_pk_fma_f32 v[164:165], v[150:151], s[66:67], v[140:141]
    v_pk_fma_f32 v[166:167], v[150:151], s[68:69], v[140:141] neg_lo:[0,0,1] neg_hi:[0,0,1]
    v_pk_fma_f32 v[170:171], v[150:151], s[72:73], v[140:141]
    v_pk_mul_f32 v[168:169], v[168:169], s[70:71]
    v_pk_fma_f32 v[164:165], v[152:153], s[72:73], v[164:165]
    v_pk_fma_f32 v[166:167], v[152:153], s[66:67], v[166:167] neg_lo:[0,1,0] neg_hi:[0,1,0]
    v_pk_fma_f32 v[170:171], v[152:153], s[68:69], v[170:171] neg_lo:[0,1,0] neg_hi:[0,1,0]
    v_pk_add_f32 v[188:189], v[172:173], v[174:175]
    v_pk_add_f32 v[194:195], v[172:173], v[178:179] neg_lo:[0,1] neg_hi:[0,1]
    v_pk_add_f32 v[196:197], v[174:175], v[178:179] neg_lo:[0,1] neg_hi:[0,1]
    v_pk_add_f32 v[188:189], v[188:189], v[178:179]
    v_pk_add_f32 v[190:191], v[82:83], v[176:177]
    v_pk_fma_f32 v[192:193], v[176:177], s[74:75], v[82:83]
    v_pk_add_f32 v[198:199], v[190:191], v[188:189]
    v_pk_fma_f32 v[204:205], v[188:189], s[74:75], v[190:191]
    v_pk_fma_f32 v[200:201], v[194:195], s[60:61], v[192:193]
    v_pk_fma_f32 v[202:203], v[194:195], s[62:63], v[192:193]
    v_pk_fma_f32 v[206:207], v[194:195], s[64:65], v[192:193]
    v_pk_fma_f32 v[200:201], v[196:197], s[62:63], v[200:201]
    v_pk_fma_f32 v[202:203], v[196:197], s[64:65], v[202:203]
    v_pk_fma_f32 v[206:207], v[196:197], s[60:61], v[206:207]
    v_pk_add_f32 v[212:213], v[180:181], v[182:183] neg_lo:[0,1] neg_hi:[0,1]
    v_pk_add_f32 v[194:195], v[180:181], v[182:183]
    v_pk_add_f32 v[196:197], v[182:183], v[186:187]
    v_pk_mul_f32 v[184:185], v[184:185], s[70:71]
    v_pk_add_f32 v[212:213], v[212:213], v[186:187]
    v_pk_fma_f32 v[208:209], v[194:195], s[66:67], v[184:185]
    v_pk_fma_f32 v[210:211], v[194:195], s[68:69], v[184:185] neg_lo:[0,0,1] neg_hi:[0,0,1]
    v_pk_fma_f32 v[214:215], v[194:195], s[72:73], v[184:185]
    v_pk_mul_f32 v[212:213], v[212:213], s[70:71]
    v_pk_fma_f32 v[208:209], v[196:197], s[72:73], v[208:209]
    v_pk_fma_f32 v[210:211], v[196:197], s[66:67], v[210:211] neg_lo:[0,1,0] neg_hi:[0,1,0]
    v_pk_fma_f32 v[214:215], v[196:197], s[68:69], v[214:215] neg_lo:[0,1,0] neg_hi:[0,1,0]
    s_cmp_lg_u32 s50, 0
    s_cbranch_scc1 Lsp_17
    s_mov_b64 exec, 0xffff
    v_cvt_pk_bf16_f32 v16, v155, 0
    ds_write_b32 v12, v16 offset:608
    v_cvt_pk_bf16_f32 v17, v157, v165
    ds_write_b32 v12, v17 offset:612
    v_cvt_pk_bf16_f32 v18, v159, v167
    ds_write_b32 v12, v18 offset:616
    v_cvt_pk_bf16_f32 v19, v161, v169
    ds_write_b32 v12, v19 offset:620
    v_cvt_pk_bf16_f32 v20, v163, v171
    ds_write_b32 v12, v20 offset:928
    v_cvt_pk_bf16_f32 v21, v163, -v171
    ds_write_b32 v12, v21 offset:288
    v_cvt_pk_bf16_f32 v22, v161, -v169
    ds_write_b32 v12, v22 offset:292
    v_cvt_pk_bf16_f32 v23, v159, -v167
    ds_write_b32 v12, v23 offset:296
    v_cvt_pk_bf16_f32 v24, v157, -v165
    ds_write_b32 v12, v24 offset:300
    v_mov_b32 v155, 0
    v_mov_b32 v157, 0
    v_mov_b32 v159, 0
    v_mov_b32 v161, 0
    v_mov_b32 v163, 0
    v_mov_b32 v165, 0
    v_mov_b32 v167, 0
    v_mov_b32 v169, 0
    v_mov_b32 v171, 0
    s_mov_b64 exec, -1
Lsp_17:
    v_pk_add_f32 v[86:87], v[200:201], v[208:209] op_sel:[0,1] op_sel_hi:[1,0] neg_lo:[0,1]
    v_cvt_pk_bf16_f32 v32, v154, v86
    v_cvt_pk_bf16_f32 v33, v155, v87
    ds_write2_b32 v116, v32, v33 offset0:0 offset1:160
    v_pk_add_f32 v[84:85], v[156:157], v[164:165] op_sel:[0,1] op_sel_hi:[1,0] neg_lo:[0,1]
    v_pk_add_f32 v[90:91], v[202:203], v[210:211] op_sel:[0,1] op_sel_hi:[1,0] neg_lo:[0,1]
    v_cvt_pk_bf16_f32 v34, v84, v90
    v_cvt_pk_bf16_f32 v35, v85, v91
    ds_write2_b32 v117, v34, v35 offset0:0 offset1:160
    v_pk_add_f32 v[88:89], v[158:159], v[166:167] op_sel:[0,1] op_sel_hi:[1,0] neg_lo:[0,1]
    v_pk_add_f32 v[94:95], v[204:205], v[212:213] op_sel:[0,1] op_sel_hi:[1,0] neg_lo:[0,1]
    v_cvt_pk_bf16_f32 v36, v88, v94
    v_cvt_pk_bf16_f32 v37, v89, v95
    ds_write2_b32 v118, v36, v37 offset0:0 offset1:160
    v_pk_add_f32 v[92:93], v[160:161], v[168:169] op_sel:[0,1] op_sel_hi:[1,0] neg_lo:[0,1]
    v_pk_add_f32 v[98:99], v[206:207], v[214:215] op_sel:[0,1] op_sel_hi:[1,0] neg_lo:[0,1]
    v_cvt_pk_bf16_f32 v38, v92, v98
    v_cvt_pk_bf16_f32 v39, v93, v99
    ds_write2_b32 v119, v38, v39 offset0:0 offset1:160
    v_pk_add_f32 v[96:97], v[162:163], v[170:171] op_sel:[0,1] op_sel_hi:[1,0] neg_lo:[0,1]
    v_pk_add_f32 v[102:103], v[206:207], v[214:215] op_sel:[0,1] op_sel_hi:[1,0] neg_hi:[0,1]
    v_cvt_pk_bf16_f32 v40, v96, v102
    v_cvt_pk_bf16_f32 v41, v97, v103
    ds_write2_b32 v120, v40, v41 offset0:0 offset1:160
    v_pk_add_f32 v[100:101], v[162:163], v[170:171] op_sel:[0,1] op_sel_hi:[1,0] neg_hi:[0,1]
    v_pk_add_f32 v[106:107], v[204:205], v[212:213] op_sel:[0,1] op_sel_hi:[1,0] neg_hi:[0,1]
    v_cvt_pk_bf16_f32 v42, v100, v106
    v_cvt_pk_bf16_f32 v43, v101, v107
    ds_write2_b32 v121, v42, v43 offset0:0 offset1:160
    v_pk_add_f32 v[104:105], v[160:161], v[168:169] op_sel:[0,1] op_sel_hi:[1,0] neg_hi:[0,1]
    v_pk_add_f32 v[110:111], v[202:203], v[210:211] op_sel:[0,1] op_sel_hi:[1,0] neg_hi:[0,1]
    v_cvt_pk_bf16_f32 v44, v104, v110
    v_cvt_pk_bf16_f32 v45, v105, v111
    ds_write2_b32 v122, v44, v45 offset0:0 offset1:160
    v_pk_add_f32 v[108:109], v[158:159], v[166:167] op_sel:[0,1] op_sel_hi:[1,0] neg_hi:[0,1]
    v_pk_add_f32 v[114:115], v[200:201], v[208:209] op_sel:[0,1] op_sel_hi:[1,0] neg_hi:[0,1]
    v_cvt_pk_bf16_f32 v46, v108, v114
    v_cvt_pk_bf16_f32 v47, v109, v115
    ds_write2_b32 v123, v46, v47 offset0:0 offset1:160
    v_pk_add_f32 v[112:113], v[156:157], v[164:165] op_sel:[0,1] op_sel_hi:[1,0] neg_hi:[0,1]
    v_cvt_pk_bf16_f32 v48, v112, v198
    v_cvt_pk_bf16_f32 v49, v113, v199
    ds_write2_b32 v124, v48, v49 offset0:0 offset1:160
    s_waitcnt lgkmcnt(0)
    s_barrier
    ds_read_b64_tr_b16 v[128:129], v14 offset:0
    ds_read_b64_tr_b16 v[130:131], v14 offset:20608
    ds_read_b64_tr_b16 v[132:133], v14 offset:8
    ds_read_b64_tr_b16 v[134:135], v14 offset:20616
    ds_read_b64_tr_b16 v[136:137], v14 offset:64
    ds_read_b64_tr_b16 v[138:139], v14 offset:20672
    ds_read_b64_tr_b16 v[140:141], v14 offset:72
    ds_read_b64_tr_b16 v[142:143], v14 offset:20680
    ds_read_b64_tr_b16 v[144:145], v14 offset:128
    ds_read_b64_tr_b16 v[146:147], v14 offset:20736
    ds_read_b64_tr_b16 v[148:149], v14 offset:136
    ds_read_b64_tr_b16 v[150:151], v14 offset:20744
    ds_read_b64_tr_b16 v[152:153], v14 offset:192
    ds_read_b64_tr_b16 v[154:155], v14 offset:20800
    ds_read_b64_tr_b16 v[156:157], v14 offset:200
    ds_read_b64_tr_b16 v[158:159], v14 offset:20808
    ds_read_b64_tr_b16 v[160:161], v14 offset:256
    ds_read_b64_tr_b16 v[162:163], v14 offset:20864
    ds_read_b64_tr_b16 v[164:165], v14 offset:264
    ds_read_b64_tr_b16 v[166:167], v14 offset:20872
    s_waitcnt lgkmcnt(15)
    v_mfma_f32_16x16x32_bf16 v[176:179], v[128:131], v[76:79], 0
    s_waitcnt lgkmcnt(15)
    v_mfma_f32_16x16x32_bf16 v[180:183], v[132:135], v[76:79], 0
    s_waitcnt lgkmcnt(14)
    v_mfma_f32_16x16x32_bf16 v[184:187], v[136:139], v[76:79], 0
    s_waitcnt lgkmcnt(12)
    v_mfma_f32_16x16x32_bf16 v[188:191], v[140:143], v[76:79], 0
    s_waitcnt lgkmcnt(10)
    v_mfma_f32_16x16x32_bf16 v[192:195], v[144:147], v[76:79], 0
    s_waitcnt lgkmcnt(8)
    v_mfma_f32_16x16x32_bf16 v[196:199], v[148:151], v[76:79], 0
    v_cvt_pk_bf16_f32 v32, v176, v177
    v_cvt_pk_bf16_f32 v33, v178, v179
    v_cvt_pk_bf16_f32 v34, v180, v181
    v_cvt_pk_bf16_f32 v35, v182, v183
    global_store_dwordx4 v15, v[32:35], s[34:35] sc1
    v_add_u32 v15, 0x10000, v15
    s_waitcnt lgkmcnt(6)
    v_mfma_f32_16x16x32_bf16 v[200:203], v[152:155], v[76:79], 0
    s_waitcnt lgkmcnt(4)
    v_mfma_f32_16x16x32_bf16 v[204:207], v[156:159], v[76:79], 0
    v_cvt_pk_bf16_f32 v36, v184, v185
    v_cvt_pk_bf16_f32 v37, v186, v187
    v_cvt_pk_bf16_f32 v38, v188, v189
    v_cvt_pk_bf16_f32 v39, v190, v191
    global_store_dwordx4 v15, v[36:39], s[34:35] sc1
    v_add_u32 v15, 0x10000, v15
    s_waitcnt lgkmcnt(2)
    v_mfma_f32_16x16x32_bf16 v[208:211], v[160:163], v[76:79], 0
    s_waitcnt lgkmcnt(0)
    v_mfma_f32_16x16x32_bf16 v[212:215], v[164:167], v[76:79], 0
    v_cvt_pk_bf16_f32 v40, v192, v193
    v_cvt_pk_bf16_f32 v41, v194, v195
    v_cvt_pk_bf16_f32 v42, v196, v197
    v_cvt_pk_bf16_f32 v43, v198, v199
    global_store_dwordx4 v15, v[40:43], s[34:35] sc1
    v_add_u32 v15, 0x10000, v15
    v_cvt_pk_bf16_f32 v44, v200, v201
    v_cvt_pk_bf16_f32 v45, v202, v203
    v_cvt_pk_bf16_f32 v46, v204, v205
    v_cvt_pk_bf16_f32 v47, v206, v207
    global_store_dwordx4 v15, v[44:47], s[34:35] sc1
    v_add_u32 v15, 0x10000, v15
    s_cmp_eq_u32 s52, 3
    s_cbranch_scc1 Lse_18
    v_cvt_pk_bf16_f32 v48, v208, v209
    v_cvt_pk_bf16_f32 v49, v210, v211
    v_cvt_pk_bf16_f32 v50, v212, v213
    v_cvt_pk_bf16_f32 v51, v214, v215
    global_store_dwordx4 v15, v[48:51], s[34:35] sc1
Lse_18:
    s_mov_b32 s78, 1
    s_mov_b32 s50, s48
    s_sub_u32 s51, s3, 4
    s_cmp_ge_u32 s51, 4
    s_addc_u32 s51, s51, 0
    s_branch L_b2go
L_b2:
    s_mov_b32 s78, 0
    s_sub_u32 s50, s48, 5
    s_lshl_b32 s50, s50, 2
    s_add_u32 s50, s50, s3
    s_mov_b32 s51, 4
    s_add_u32 s26, s34, 5308416
    s_addc_u32 s27, s35, 0
    s_load_dwordx2 s[28:29], s[26:27], 0
    s_waitcnt lgkmcnt(0)
    s_barrier
    s_mul_i32 s28, s28, 0x9e3779b1
    s_add_u32 s28, s28, 0x7f4a7c15
    s_mul_i32 s29, s29, 0x85ebca6d
    s_add_u32 s29, s29, 0x165667b1
    s_lshl_b32 s49, s48, 3
    s_add_u32 s49, s49, s6
    s_lshl_b32 s49, s49, 7
    s_add_u32 s49, s49, 5312512
    v_lshl_add_u32 v29, v1, 3, s49
    v_mov_b32 v30, 0
    v_mov_b32 v31, 0
L_b2go:
    s_setprio 0
    s_mov_b64 s[56:57], s[34:35]
    s_mov_b32 s58, 268435456
    s_mov_b32 s59, 0x20000
    v_and_b32 v2, 15, v1
    v_lshrrev_b32 v3, 4, v1
    s_lshr_b32 s52, s6, 2
    s_lshl_b32 s53, s50, 1
    s_add_u32 s53, s53, s52
    s_and_b32 s49, s6, 3
    s_lshl_b32 s55, s49, 9
    s_add_u32 s55, s55, s53
    s_lshl_b32 s65, s52, 1
    s_lshr_b32 s66, s49, 1
    s_mul_i32 s67, s66, -1008
    s_add_u32 s67, s67, s55
    s_cmp_eq_u32 s53, 0
    s_cselect_b32 s54, 0, -1
    s_cselect_b32 s55, s67, s55
    s_cselect_b32 s65, s66, s65
    v_lshl_add_u32 v56, v2, 5, s55
    v_cvt_f32_u32 v56, v56
    v_mul_f32 v56, 0x3a000000, v56
    v_lshlrev_b32 v58, 3, v3
    v_cvt_f32_u32 v58, v58
    v_mul_f32 v57, v56, v58
    v_mul_f32 v59, 0x41c00000, v56
    v_cos_f32 v60, v57
    v_sin_f32 v62, v57
    v_add_f32 v57, v57, v56
    v_cos_f32 v61, v57
    v_sin_f32 v63, v57
    v_add_f32 v57, v57, v56
    v_cvt_pk_bf16_f32 v64, v60, v61
    v_cvt_pk_bf16_f32 v80, v62, v63
    v_mov_b32 v88, v64
    v_xor_b32 v72, 0x80008000, v80
    v_cos_f32 v60, v57
    v_sin_f32 v62, v57
    v_add_f32 v57, v57, v56
    v_cos_f32 v61, v57
    v_sin_f32 v63, v57
    v_add_f32 v57, v57, v56
    v_cvt_pk_bf16_f32 v65, v60, v61
    v_cvt_pk_bf16_f32 v81, v62, v63
    v_mov_b32 v89, v65
    v_xor_b32 v73, 0x80008000, v81
    v_cos_f32 v60, v57
    v_sin_f32 v62, v57
    v_add_f32 v57, v57, v56
    v_cos_f32 v61, v57
    v_sin_f32 v63, v57
    v_add_f32 v57, v57, v56
    v_cvt_pk_bf16_f32 v66, v60, v61
    v_cvt_pk_bf16_f32 v82, v62, v63
    v_mov_b32 v90, v66
    v_xor_b32 v74, 0x80008000, v82
    v_cos_f32 v60, v57
    v_sin_f32 v62, v57
    v_add_f32 v57, v57, v56
    v_cos_f32 v61, v57
    v_sin_f32 v63, v57
    v_add_f32 v57, v57, v56
    v_cvt_pk_bf16_f32 v67, v60, v61
    v_cvt_pk_bf16_f32 v83, v62, v63
    v_mov_b32 v91, v67
    v_xor_b32 v75, 0x80008000, v83
    v_add_f32 v57, v57, v59
    v_cos_f32 v60, v57
    v_sin_f32 v62, v57
    v_add_f32 v57, v57, v56
    v_cos_f32 v61, v57
    v_sin_f32 v63, v57
    v_add_f32 v57, v57, v56
    v_cvt_pk_bf16_f32 v68, v60, v61
    v_cvt_pk_bf16_f32 v84, v62, v63
    v_mov_b32 v92, v68
    v_xor_b32 v76, 0x80008000, v84
    v_cos_f32 v60, v57
    v_sin_f32 v62, v57
    v_add_f32 v57, v57, v56
    v_cos_f32 v61, v57
    v_sin_f32 v63, v57
    v_add_f32 v57, v57, v56
    v_cvt_pk_bf16_f32 v69, v60, v61
    v_cvt_pk_bf16_f32 v85, v62, v63
    v_mov_b32 v93, v69
    v_xor_b32 v77, 0x80008000, v85
    v_cos_f32 v60, v57
    v_sin_f32 v62, v57
    v_add_f32 v57, v57, v56
    v_cos_f32 v61, v57
    v_sin_f32 v63, v57
    v_add_f32 v57, v57, v56
    v_cvt_pk_bf16_f32 v70, v60, v61
    v_cvt_pk_bf16_f32 v86, v62, v63
    v_mov_b32 v94, v70
    v_xor_b32 v78, 0x80008000, v86
    v_cos_f32 v60, v57
    v_sin_f32 v62, v57
    v_add_f32 v57, v57, v56
    v_cos_f32 v61, v57
    v_sin_f32 v63, v57
    v_add_f32 v57, v57, v56
    v_cvt_pk_bf16_f32 v71, v60, v61
    v_cvt_pk_bf16_f32 v87, v62, v63
    v_mov_b32 v95, v71
    v_xor_b32 v79, 0x80008000, v87
    s_cmp_lg_u32 s53, 0
    s_cbranch_scc1 L_bm
    v_mov_b32 v72, 0
    v_mov_b32 v88, 0
    v_mov_b32 v73, 0
    v_mov_b32 v89, 0
    v_mov_b32 v74, 0
    v_mov_b32 v90, 0
    v_mov_b32 v75, 0
    v_mov_b32 v91, 0
    v_mov_b32 v76, 0
    v_mov_b32 v92, 0
    v_mov_b32 v77, 0
    v_mov_b32 v93, 0
    v_mov_b32 v78, 0
    v_mov_b32 v94, 0
    v_mov_b32 v79, 0
    v_mov_b32 v95, 0
L_bm:
    s_waitcnt vmcnt(0)
    v_mov_b32 v126, 137600
    v_mov_b32 v127, 1
    s_mov_b64 exec, 1
    ds_add_rtn_u32 v126, v126, v127
    s_waitcnt lgkmcnt(0)
    v_cmp_eq_u32 vcc, 7, v126
    s_nop 0
    s_cbranch_vccz L_bpub
    s_cmp_eq_u32 s78, 0
    s_cbranch_scc1 L_bp2
    s_mov_b64 exec, 255
    s_bfe_u32 s49, s7, 0x30002
    s_lshl_b32 s49, s49, 7
    s_and_b32 s69, s7, 3
    s_lshl_b32 s69, s69, 3
    s_add_u32 s49, s49, s69
    s_and_b32 s69, s7, 32
    s_add_u32 s49, s49, s69
    s_add_u32 s49, s49, 5312512
    v_lshl_add_u32 v125, v1, 10, s49
    v_mov_b32 v126, s28
    v_mov_b32 v127, s29
    global_atomic_swap_x2 v125, v[126:127], s[34:35] sc1
    s_mov_b64 exec, 1
L_bp2:
    s_lshl_b32 s49, s2, 7
    s_add_u32 s49, s49, 5242880
    v_mov_b32 v125, s49
    v_mov_b32 v126, s28
    v_mov_b32 v127, s29
    v_add_u32 v125, 32768, v125
    global_store_dwordx2 v125, v[126:127], s[34:35] sc1
L_bpub:
    s_mov_b64 exec, -1
    s_mul_i32 s49, s50, 19
    s_lshl_b32 s60, s51, 1
    s_add_u32 s60, s60, s49
    s_lshl_b32 s60, s60, 14
    s_add_u32 s60, s60, 2359296
    s_add_u32 s61, s60, 8192
    s_add_u32 s62, s60, 16384
    s_add_u32 s63, s60, 24576
    s_add_u32 s49, s49, 18
    s_lshl_b32 s64, s49, 14
    s_add_u32 s64, s64, 2359296
    s_lshr_b32 s49, s51, 2
    s_lshl_b32 s49, s49, 6
    s_add_u32 s64, s64, s49
    s_and_b32 s49, s51, 3
    s_lshl_b32 s49, s49, 2
    s_add_u32 s64, s64, s49
    v_lshlrev_b32 v4, 4, v0
    v_bfe_u32 v9, v1, 2, 2
    v_bfe_u32 v10, v1, 4, 1
    v_lshl_add_u32 v9, v10, 5, v9
    s_lshl_b32 s49, s6, 2
    v_add_u32 v9, s49, v9
    v_and_b32 v10, 3, v0
    v_lshlrev_b32 v5, 8, v9
    v_lshl_add_u32 v5, v10, 4, v5
    v_and_b32 v7, 35, v9
    v_bfe_u32 v11, v9, 2, 1
    v_lshl_add_u32 v7, v11, 4, v7
    v_bfe_u32 v11, v9, 3, 2
    v_lshl_add_u32 v7, v11, 2, v7
    v_mul_u32_u24 v7, 544, v7
    v_lshl_add_u32 v7, v10, 3, v7
    v_add_u32 v7, 78592, v7
    v_lshrrev_b32 v9, 4, v0
    v_and_b32 v6, 35, v9
    v_bfe_u32 v11, v9, 2, 1
    v_lshl_add_u32 v6, v11, 4, v6
    v_bfe_u32 v11, v9, 3, 2
    v_lshl_add_u32 v6, v11, 2, v6
    v_mul_u32_u24 v6, 544, v6
    v_lshl_add_u32 v6, v10, 5, v6
    v_bfe_u32 v11, v0, 2, 2
    v_lshl_add_u32 v6, v11, 7, v6
    v_and_b32 v11, 1, v11
    v_lshl_add_u32 v6, v11, 4, v6
    v_add_u32 v6, 78080, v6
    v_xor_b32 v12, 16, v6
    s_lshl_b32 s49, s65, 3
    s_lshl_b32 s65, s65, 5
    v_lshrrev_b32 v9, 2, v1
    v_mul_u32_u24 v9, 544, v9
    v_add_u32 v9, 78080, v9
    v_lshl_add_u32 v8, v10, 3, v9
    v_add_u32 v8, s65, v8
    v_xor_b32 v13, 16, v8
    v_add_u32 v9, s49, v9
    v_cmp_eq_u32 vcc, 3, v10
    v_add_u32 v11, 8, v8
    v_add_u32 v28, 512, v9
    v_cndmask_b32 v16, v11, v28, vcc
    v_add_u32 v11, 40, v8
    v_add_u32 v28, 520, v9
    v_cndmask_b32 v17, v11, v28, vcc
    v_add_u32 v11, 264, v8
    v_add_u32 v28, 512, v9
    v_cndmask_b32 v18, v11, v28, vcc
    v_add_u32 v11, 296, v8
    v_add_u32 v28, 520, v9
    v_cndmask_b32 v19, v11, v28, vcc
    s_lshl_b32 s49, s6, 12
    v_lshrrev_b32 v11, 1, v2
    v_add_u32 v11, v11, v3
    v_and_b32 v11, 3, v11
    v_lshlrev_b32 v11, 4, v11
    v_lshl_add_u32 v20, v2, 6, v11
    v_add_u32 v20, s49, v20
    v_lshrrev_b32 v9, 2, v1
    v_lshrrev_b32 v11, 3, v1
    v_add_u32 v21, v11, v10
    v_and_b32 v21, 3, v21
    v_sub_u32 v22, v11, v10
    v_add_u32 v22, 3, v22
    v_and_b32 v22, 3, v22
    v_lshlrev_b32 v11, 6, v9
    v_add_u32 v11, s49, v11
    v_lshl_add_u32 v21, v21, 4, v11
    v_lshl_add_u32 v22, v22, 4, v11
    s_movk_i32 s68, 2304
    v_lshl_add_u32 v9, v9, 5, s55
    v_sub_u32 v11, 2048, v9
    v_mov_b32 v28, 1024
    v_cmp_eq_u32 vcc, 0, v9
    v_lshlrev_b32 v10, 4, v10
    v_add_u32 v10, 1152, v10
    v_cndmask_b32 v11, v11, v28, vcc
    v_mad_u32_u24 v23, v9, s68, v10
    v_mad_u32_u24 v24, v11, s68, v10
    s_lshl_b32 s66, s51, 7
    s_sub_u32 s67, 1088, s66
    v_add_u32 v25, s67, v23
    v_add_u32 v26, s67, v24
    v_add_u32 v23, s66, v23
    v_add_u32 v24, s66, v24
    v_mov_b32 v124, 0
    v_mov_b32 v125, 0
    s_mov_b64 exec, 255
    s_mov_b32 s49, 0
La_19:
    global_atomic_add_x2 v[126:127], v29, v[124:125], s[34:35] sc0 sc1
    s_add_u32 s49, s49, 1
    s_cmp_gt_u32 s49, 0x100000
    s_waitcnt vmcnt(0)
    v_cmp_ne_u64 vcc, s[28:29], v[126:127]
    s_cbranch_scc1 Lax_20
    s_cbranch_vccnz La_19
Lax_20:
    s_mov_b64 exec, -1
    buffer_load_dword v112, v5, s[56:59], s64 offen sc1
    buffer_load_dwordx4 v[96:99], v4, s[56:59], s60 offen sc1
    buffer_load_dwordx4 v[100:103], v4, s[56:59], s62 offen sc1
    buffer_load_dwordx4 v[104:107], v4, s[56:59], s61 offen sc1
    buffer_load_dwordx4 v[108:111], v4, s[56:59], s63 offen sc1
    s_waitcnt vmcnt(4)
    ds_write_b32 v7, v112
    s_waitcnt vmcnt(3)
    ds_write_b128 v6, v[96:99] offset:0
    s_waitcnt vmcnt(2)
    ds_write_b128 v12, v[100:103] offset:0
    s_waitcnt vmcnt(1)
    ds_write_b128 v6, v[104:107] offset:17408
    s_waitcnt vmcnt(0)
    ds_write_b128 v12, v[108:111] offset:17408
    s_waitcnt lgkmcnt(0)
    s_barrier
    ds_read_b64_tr_b16 v[128:129], v8 offset:0
    ds_read_b64_tr_b16 v[130:131], v8 offset:8704
    ds_read_b64_tr_b16 v[132:133], v13 offset:128
    ds_read_b64_tr_b16 v[134:135], v13 offset:8832
    ds_read_b64_tr_b16 v[136:137], v16 offset:0
    ds_read_b64_tr_b16 v[138:139], v16 offset:8704
    ds_read_b64_tr_b16 v[140:141], v8 offset:256
    ds_read_b64_tr_b16 v[142:143], v8 offset:8960
    ds_read_b64_tr_b16 v[144:145], v13 offset:384
    ds_read_b64_tr_b16 v[146:147], v13 offset:9088
    ds_read_b64_tr_b16 v[148:149], v18 offset:0
    ds_read_b64_tr_b16 v[150:151], v18 offset:8704
    ds_read_b64_tr_b16 v[152:153], v8 offset:32
    ds_read_b64_tr_b16 v[154:155], v8 offset:8736
    s_waitcnt lgkmcnt(12)
    v_mfma_f32_16x16x32_bf16 v[32:35], v[128:131], v[64:67], 0
    ds_read_b64_tr_b16 v[156:157], v13 offset:160
    ds_read_b64_tr_b16 v[158:159], v13 offset:8864
    s_waitcnt lgkmcnt(12)
    v_mfma_f32_16x16x32_bf16 v[36:39], v[132:135], v[64:67], 0
    ds_read_b64_tr_b16 v[160:161], v17 offset:0
    ds_read_b64_tr_b16 v[162:163], v17 offset:8704
    s_waitcnt lgkmcnt(12)
    v_mfma_f32_16x16x32_bf16 v[40:43], v[136:139], v[64:67], 0
    ds_read_b64_tr_b16 v[164:165], v8 offset:288
    ds_read_b64_tr_b16 v[166:167], v8 offset:8992
    s_waitcnt lgkmcnt(12)
    v_mfma_f32_16x16x32_bf16 v[44:47], v[140:143], v[80:83], 0
    ds_read_b64_tr_b16 v[168:169], v13 offset:416
    ds_read_b64_tr_b16 v[170:171], v13 offset:9120
    s_waitcnt lgkmcnt(12)
    v_mfma_f32_16x16x32_bf16 v[48:51], v[144:147], v[80:83], 0
    ds_read_b64_tr_b16 v[172:173], v19 offset:0
    ds_read_b64_tr_b16 v[174:175], v19 offset:8704
    s_waitcnt lgkmcnt(12)
    v_mfma_f32_16x16x32_bf16 v[52:55], v[148:151], v[80:83], 0
    ds_read_b64_tr_b16 v[176:177], v8 offset:17408
    ds_read_b64_tr_b16 v[178:179], v8 offset:26112
    s_waitcnt lgkmcnt(12)
    v_mfma_f32_16x16x32_bf16 v[32:35], v[152:155], v[72:75], v[32:35]
    ds_read_b64_tr_b16 v[180:181], v13 offset:17536
    ds_read_b64_tr_b16 v[182:183], v13 offset:26240
    s_waitcnt lgkmcnt(12)
    v_mfma_f32_16x16x32_bf16 v[36:39], v[156:159], v[72:75], v[36:39]
    ds_read_b64_tr_b16 v[184:185], v16 offset:17408
    ds_read_b64_tr_b16 v[186:187], v16 offset:26112
    s_waitcnt lgkmcnt(12)
    v_mfma_f32_16x16x32_bf16 v[40:43], v[160:163], v[72:75], v[40:43]
    ds_read_b64_tr_b16 v[188:189], v8 offset:17664
    ds_read_b64_tr_b16 v[190:191], v8 offset:26368
    s_waitcnt lgkmcnt(12)
    v_mfma_f32_16x16x32_bf16 v[44:47], v[164:167], v[88:91], v[44:47]
    ds_read_b64_tr_b16 v[192:193], v13 offset:17792
    ds_read_b64_tr_b16 v[194:195], v13 offset:26496
    s_waitcnt lgkmcnt(12)
    v_mfma_f32_16x16x32_bf16 v[48:51], v[168:171], v[88:91], v[48:51]
    ds_read_b64_tr_b16 v[196:197], v18 offset:17408
    ds_read_b64_tr_b16 v[198:199], v18 offset:26112
    s_waitcnt lgkmcnt(12)
    v_mfma_f32_16x16x32_bf16 v[52:55], v[172:175], v[88:91], v[52:55]
    ds_read_b64_tr_b16 v[200:201], v8 offset:17440
    ds_read_b64_tr_b16 v[202:203], v8 offset:26144
    s_waitcnt lgkmcnt(12)
    v_mfma_f32_16x16x32_bf16 v[32:35], v[176:179], v[68:71], v[32:35]
    ds_read_b64_tr_b16 v[204:205], v13 offset:17568
    ds_read_b64_tr_b16 v[206:207], v13 offset:26272
    s_waitcnt lgkmcnt(12)
    v_mfma_f32_16x16x32_bf16 v[36:39], v[180:183], v[68:71], v[36:39]
    ds_read_b64_tr_b16 v[208:209], v17 offset:17408
    ds_read_b64_tr_b16 v[210:211], v17 offset:26112
    s_waitcnt lgkmcnt(12)
    v_mfma_f32_16x16x32_bf16 v[40:43], v[184:187], v[68:71], v[40:43]
    ds_read_b64_tr_b16 v[212:213], v8 offset:17696
    ds_read_b64_tr_b16 v[214:215], v8 offset:26400
    s_waitcnt lgkmcnt(12)
    v_mfma_f32_16x16x32_bf16 v[44:47], v[188:191], v[84:87], v[44:47]
    ds_read_b64_tr_b16 v[216:217], v13 offset:17824
    ds_read_b64_tr_b16 v[218:219], v13 offset:26528
    s_waitcnt lgkmcnt(12)
    v_mfma_f32_16x16x32_bf16 v[48:51], v[192:195], v[84:87], v[48:51]
    ds_read_b64_tr_b16 v[220:221], v19 offset:17408
    ds_read_b64_tr_b16 v[222:223], v19 offset:26112
    s_waitcnt lgkmcnt(12)
    v_mfma_f32_16x16x32_bf16 v[52:55], v[196:199], v[84:87], v[52:55]
    s_waitcnt lgkmcnt(10)
    v_mfma_f32_16x16x32_bf16 v[32:35], v[200:203], v[76:79], v[32:35]
    s_waitcnt lgkmcnt(8)
    v_mfma_f32_16x16x32_bf16 v[36:39], v[204:207], v[76:79], v[36:39]
    s_waitcnt lgkmcnt(6)
    v_mfma_f32_16x16x32_bf16 v[40:43], v[208:211], v[76:79], v[40:43]
    s_waitcnt lgkmcnt(4)
    v_mfma_f32_16x16x32_bf16 v[44:47], v[212:215], v[92:95], v[44:47]
    s_waitcnt lgkmcnt(2)
    v_mfma_f32_16x16x32_bf16 v[48:51], v[216:219], v[92:95], v[48:51]
    s_waitcnt lgkmcnt(0)
    v_mfma_f32_16x16x32_bf16 v[52:55], v[220:223], v[92:95], v[52:55]
    v_cmp_eq_u32 vcc, 3, v3
    s_nop 6
    v_cndmask_b32 v52, v52, v53, vcc
    v_pk_add_f32 v[96:97], v[32:33], v[44:45] neg_lo:[0,1] neg_hi:[0,1]
    v_pk_add_f32 v[106:107], v[32:33], v[44:45]
    v_pk_add_f32 v[98:99], v[34:35], v[46:47] neg_lo:[0,1] neg_hi:[0,1]
    v_pk_add_f32 v[108:109], v[34:35], v[46:47]
    v_pk_add_f32 v[100:101], v[36:37], v[48:49] neg_lo:[0,1] neg_hi:[0,1]
    v_pk_add_f32 v[110:111], v[36:37], v[48:49]
    v_pk_add_f32 v[102:103], v[38:39], v[50:51] neg_lo:[0,1] neg_hi:[0,1]
    v_pk_add_f32 v[112:113], v[38:39], v[50:51]
    v_sub_f32 v104, v40, v52
    v_add_f32 v114, v40, v52
    v_cvt_pk_bf16_f32 v224, v96, v97
    v_cvt_pk_bf16_f32 v225, v98, v99
    v_cvt_pk_bf16_f32 v226, v100, v101
    v_cvt_pk_bf16_f32 v227, v102, v103
    ds_write_b128 v20, v[224:227] offset:0
    v_cvt_pk_bf16_f32 v228, v114, v113
    v_cvt_pk_bf16_f32 v229, v112, v111
    v_cvt_pk_bf16_f32 v230, v110, v109
    v_cvt_pk_bf16_f32 v231, v108, v107
    ds_write_b128 v20, v[228:231] offset:1024
    s_cmp_lg_u32 s55, 0
    s_cbranch_scc1 L_nz
    v_mov_b32 v56, 0xbf803f80
    v_mov_b32 v57, 0xbf803f80
    v_mov_b32 v58, 0xbf803f80
    v_mov_b32 v59, 0xbf803f80
    s_nop 1
    v_mfma_f32_16x16x32_bf16 v[32:35], v[128:131], v[56:59], 0
    v_mfma_f32_16x16x32_bf16 v[36:39], v[132:135], v[56:59], 0
    v_mfma_f32_16x16x32_bf16 v[40:43], v[136:139], v[56:59], 0
    v_mfma_f32_16x16x32_bf16 v[32:35], v[176:179], v[56:59], v[32:35]
    v_mfma_f32_16x16x32_bf16 v[36:39], v[180:183], v[56:59], v[36:39]
    v_mfma_f32_16x16x32_bf16 v[40:43], v[184:187], v[56:59], v[40:43]
    s_mov_b32 exec_lo, 0x10001
    s_mov_b32 exec_hi, 0x10001
    s_nop 7
    v_mov_b32 v96, v32
    v_mov_b32 v106, v32
    v_mov_b32 v97, v33
    v_mov_b32 v107, v33
    v_mov_b32 v98, v34
    v_mov_b32 v108, v34
    v_mov_b32 v99, v35
    v_mov_b32 v109, v35
    v_mov_b32 v100, v36
    v_mov_b32 v110, v36
    v_mov_b32 v101, v37
    v_mov_b32 v111, v37
    v_mov_b32 v102, v38
    v_mov_b32 v112, v38
    v_mov_b32 v103, v39
    v_mov_b32 v113, v39
    v_mov_b32 v104, v40
    v_mov_b32 v114, v40
    s_mov_b64 exec, -1
L_nz:
    v_cvt_pk_bf16_f32 v232, v106, v107
    v_cvt_pk_bf16_f32 v233, v108, v109
    v_cvt_pk_bf16_f32 v234, v110, v111
    v_cvt_pk_bf16_f32 v235, v112, v113
    ds_write_b128 v20, v[232:235] offset:2048
    v_cvt_pk_bf16_f32 v236, v104, v103
    v_cvt_pk_bf16_f32 v237, v102, v101
    v_cvt_pk_bf16_f32 v238, v100, v99
    v_cvt_pk_bf16_f32 v239, v98, v97
    ds_write_b128 v20, v[236:239] offset:3072
    s_waitcnt lgkmcnt(0)
    ds_read_b128 v[144:147], v21 offset:0
    ds_read_b128 v[148:151], v22 offset:1024
    ds_read_b128 v[152:155], v21 offset:2048
    ds_read_b128 v[156:159], v22 offset:3072
    s_waitcnt lgkmcnt(3)
    global_store_dwordx4 v23, v[144:147], s[30:31]
    s_waitcnt lgkmcnt(2)
    global_store_dwordx4 v25, v[148:151], s[30:31]
    s_waitcnt lgkmcnt(1)
    global_store_dwordx4 v24, v[152:155], s[30:31]
    s_waitcnt lgkmcnt(0)
    global_store_dwordx4 v26, v[156:159], s[30:31]
L_fin:
L_end:
    s_endpgm
.fill 64, 4, 0xbf800000
.section .rodata,"a"
.p2align 6
.amdhsa_kernel concat_heads__ssm_conv_h3__spectral_fnet__prompt_kernel
.amdhsa_next_free_vgpr 256
.amdhsa_next_free_sgpr 102
.amdhsa_accum_offset 256
.amdhsa_group_segment_fixed_size 0
.amdhsa_kernarg_size 112
.amdhsa_user_sgpr_count 2
.amdhsa_user_sgpr_kernarg_segment_ptr 1
.amdhsa_system_sgpr_workgroup_id_x 1
.amdhsa_float_denorm_mode_32 3
.end_amdhsa_kernel
```
